```python
import torch

def _softmax(x, axis=-1):
    return torch.softmax(x, dim=axis)
def _gelu(x):
    return torch.nn.functional.gelu(x, approximate="tanh")
def _silu(x):
    return torch.nn.functional.silu(x)
def _sigmoid(x):
    return torch.sigmoid(x)
def _layernorm(x, axis=-1, eps=1e-5):
    m = x.mean(dim=axis, keepdim=True)
    v = x.var(dim=axis, keepdim=True, unbiased=False)
    return (x - m) / torch.sqrt(v + eps)
def _scatter_add(tgt, idx, src, axis=0):
    return tgt.clone().index_add_(axis, idx, src)
def _segment_sum(src, seg, n):
    out = torch.zeros((n,) + src.shape[1:], dtype=src.dtype)
    return out.index_add_(0, seg, src)
def _pad(x, pw):
    flat = tuple(v for pair in reversed(pw) for v in pair)
    return torch.nn.functional.pad(x, flat)

kernel_name = 'standalone__gqa_softmax__near_ridge'

def setup_inputs():

    _w = (lambda a: (lambda t: t.to(torch.bfloat16) if t.is_floating_point() else t)(torch.as_tensor(a)))
    B, Hq, Hkv, Sq, Sk, D = 8, 16, 8, 128, 1024, 256
    return {
        "q": _w((lambda *s: torch.randn(*s, dtype=torch.bfloat16) * 0.8)(B, Hq, Sq, D)),
        "k": _w((lambda *s: torch.randn(*s, dtype=torch.bfloat16) * 0.8)(B, Hkv, Sk, D)),
        "v": _w((lambda *s: torch.randn(*s, dtype=torch.bfloat16) * 0.05)(B, Hkv, Sk, D)),
    }

def reference(q, k, v):
    B, Hq, Sq, D = q.shape
    Hkv = k.shape[1]
    rep = Hq // Hkv
    k = (lambda x, n, axis: torch.repeat_interleave(x, n, dim=axis))(k, rep, axis=1)
    v = (lambda x, n, axis: torch.repeat_interleave(x, n, dim=axis))(v, rep, axis=1)
    scale = D ** -0.5
    scores = torch.einsum("bhqd,bhkd->bhqk", q, k) * scale
    p = _softmax(scores, axis=-1)
    return torch.einsum("bhqk,bhkd->bhqd", p, v)
```

```asm
; @launch grid=(256,1,1) block=(256,1,1) lds=163840
.amdgcn_target "amdgcn-amd-amdhsa--gfx950"
.text
.globl standalone__gqa_softmax__near_ridge_kernel
.p2align 8
.type standalone__gqa_softmax__near_ridge_kernel,@function
standalone__gqa_softmax__near_ridge_kernel:
    s_cmp_ge_u32 s2, 0x100
    s_cbranch_scc1 L_end
    s_memrealtime s[40:41]
    s_load_dwordx8 s[4:11], s[0:1], 0
    s_load_dwordx2 s[12:13], s[0:1], 40
    s_getreg_b32 s49, hwreg(HW_REG_XCC_ID, 0, 4)
    s_and_b32 s66, s2, 7
    s_lshr_b32 s67, s2, 5
    s_lshl_b32 s67, s67, 3
    s_or_b32 s66, s66, s67
    s_bfe_u32 s67, s2, 0x10003
    s_lshl_b32 s68, s66, 1
    s_add_u32 s68, s68, s67
    s_lshl_b32 s68, s68, 18
    s_bfe_u32 s69, s2, 0x10004
    s_lshl_b32 s66, s66, 1
    s_add_u32 s69, s69, s66
    s_lshl_b32 s69, s69, 16
    v_lshrrev_b32 v1, 6, v0
    v_and_b32 v0, 63, v0
    v_readfirstlane_b32 s32, v1
    s_getpc_b64 s[70:71]
L_pc:
    s_lshr_b32 s74, s2, 3
    s_mul_i32 s74, s74, 3
    v_min_u32 v38, 2, v0
    v_add_u32 v38, s74, v38
    v_lshlrev_b32 v38, 7, v38
    v_min_u32 v38, L_rare0-L_pc, v38
    v_cmp_le_u32 vcc, L_loopA-L_pc, v38
    v_add_u32 v39, L_tail-L_loopA, v38
    s_nop 0
    v_cndmask_b32 v38, v38, v39, vcc
    v_min_u32 v38, L_rare0-L_pc, v38
    v_mov_b32 v39, s71
    v_add_co_u32 v38, vcc, s70, v38
    s_nop 1
    v_addc_co_u32 v39, vcc, 0, v39, vcc
    global_load_dword a134, v[38:39], off
    v_lshrrev_b32 v12, 5, v0
    v_and_b32 v13, 31, v0
    s_lshl_b32 s73, s67, 8
    v_lshlrev_b32 v14, 9, v12
    v_xor_b32 v14, s73, v14
    v_and_b32 v15, 1, v1
    v_lshl_add_u32 v15, v15, 3, v12
    v_add_u32 v24, 0, v15
    v_xor_b32 v24, v24, v13
    v_lshlrev_b32 v24, 4, v24
    v_xor_b32 v24, v24, v14
    v_add_u32 v25, 2, v15
    v_xor_b32 v25, v25, v13
    v_lshlrev_b32 v25, 4, v25
    v_xor_b32 v25, v25, v14
    v_add_u32 v26, 4, v15
    v_xor_b32 v26, v26, v13
    v_lshlrev_b32 v26, 4, v26
    v_xor_b32 v26, v26, v14
    v_add_u32 v27, 6, v15
    v_xor_b32 v27, v27, v13
    v_lshlrev_b32 v27, 4, v27
    v_xor_b32 v27, v27, v14
    v_lshrrev_b32 v32, 3, v0
    v_lshlrev_b32 v32, 9, v32
    v_lshl_add_u32 v32, v1, 14, v32
    v_lshrrev_b32 v33, 4, v0
    v_and_b32 v34, 7, v0
    v_xor_b32 v33, v33, v34
    v_xor_b32 v44, 0, v33
    v_lshl_add_u32 v44, v44, 4, v32
    v_xor_b32 v45, 4, v33
    v_lshl_add_u32 v45, v45, 4, v32
    v_add_u32 v45, 3072, v45
    v_xor_b32 v46, 0, v33
    v_lshl_add_u32 v46, v46, 4, v32
    v_add_u32 v46, 6144, v46
    v_xor_b32 v47, 4, v33
    v_lshl_add_u32 v47, v47, 4, v32
    v_add_u32 v47, 9216, v47
    s_lshl_b32 s35, s32, 12
    s_add_u32 s36, s35, 0xc000
    s_lshl_b32 s72, s32, 14
    s_cmp_lt_u32 s32, 2
    s_cselect_b32 s71, 8, 3
    s_lshl_b32 s71, s71, 14
    s_add_u32 s72, s72, s71
    s_waitcnt lgkmcnt(0)
    s_add_u32 s20, s6, s68
    s_addc_u32 s21, s7, 0
    s_mov_b32 s22, 262144
    s_mov_b32 s23, 0x20000
    s_add_u32 s16, s4, s69
    s_addc_u32 s17, s5, 0
    s_mov_b32 s18, 0x10000
    s_mov_b32 s19, 0x20000
    s_pack_ll_b32_b16 m0, s35, 0
    s_nop 0
    buffer_load_dwordx4 v24, s[20:23], s35 offen nt lds
    buffer_load_dwordx4 v25, s[20:23], s35 offen offset:1024 nt lds
    buffer_load_dwordx4 v26, s[20:23], s35 offen offset:2048 nt lds
    buffer_load_dwordx4 v27, s[20:23], s35 offen offset:3072 nt lds
    s_add_u32 s35, s35, 0x4000
    s_pack_ll_b32_b16 m0, s35, 0
    s_nop 0
    buffer_load_dwordx4 v24, s[20:23], s35 offen nt lds
    buffer_load_dwordx4 v25, s[20:23], s35 offen offset:1024 nt lds
    buffer_load_dwordx4 v26, s[20:23], s35 offen offset:2048 nt lds
    buffer_load_dwordx4 v27, s[20:23], s35 offen offset:3072 nt lds
    s_add_u32 s35, s35, 0x4000
    s_add_u32 m0, s72, 0
    s_xor_b32 s71, s73, 0
    buffer_load_dwordx4 v44, s[16:19], s71 offen lds
    buffer_load_dwordx4 v45, s[16:19], s71 offen offset:1024 lds
    buffer_load_dwordx4 v46, s[16:19], s71 offen offset:2048 lds
    buffer_load_dwordx4 v47, s[16:19], s71 offen offset:3072 lds
    s_sub_u32 s70, s68, 49152
    s_ashr_i32 s74, s70, 31
    s_add_u32 s24, s8, s70
    s_addc_u32 s25, s9, s74
    s_mov_b32 s26, 311296
    s_mov_b32 s27, 0x20000
    s_add_u32 s28, s10, s69
    s_addc_u32 s29, s11, 0
    s_mov_b32 s30, 0x10000
    s_mov_b32 s31, 0x20000
    s_add_u32 s12, s12, 1048576
    s_addc_u32 s13, s13, 0
    s_mov_b32 s14, 393216
    s_mov_b32 s15, 0x20000
    s_lshl_b32 s70, s2, 2
    s_add_u32 s70, s70, s32
    s_xor_b32 s74, s70, 32
    s_lshl_b32 s45, s70, 7
    s_add_u32 s45, s45, 262144
    s_lshl_b32 s46, s74, 7
    s_add_u32 s46, s46, 262144
    s_lshl_b32 s47, s70, 8
    s_lshl_b32 s48, s74, 8
    s_lshl_b64 s[40:41], s[40:41], 4
    s_or_b32 s40, s40, s49
    v_mov_b32 v42, s40
    v_mov_b32 v43, s41
    buffer_store_dwordx2 v[42:43], off, s[12:15], s46 sc1
    v_xor_b32 v14, 0x100, v14
    v_add_u32 v28, 0, v12
    v_lshlrev_b32 v28, 1, v28
    v_xor_b32 v28, v28, v13
    v_lshlrev_b32 v28, 4, v28
    v_xor_b32 v28, v28, v14
    v_add_u32 v29, 2, v12
    v_lshlrev_b32 v29, 1, v29
    v_xor_b32 v29, v29, v13
    v_lshlrev_b32 v29, 4, v29
    v_xor_b32 v29, v29, v14
    v_add_u32 v30, 4, v12
    v_lshlrev_b32 v30, 1, v30
    v_xor_b32 v30, v30, v13
    v_lshlrev_b32 v30, 4, v30
    v_xor_b32 v30, v30, v14
    v_add_u32 v31, 6, v12
    v_lshlrev_b32 v31, 1, v31
    v_xor_b32 v31, v31, v13
    v_lshlrev_b32 v31, 4, v31
    v_xor_b32 v31, v31, v14
    s_lshl_b32 s51, s32, 14
    s_add_u32 s51, s51, s73
    s_xor_b32 s52, s51, 0x100
    s_add_u32 s53, s51, 0
    s_add_u32 s57, s52, 0
    s_add_u32 s54, s51, 4096
    s_add_u32 s58, s52, 4096
    s_add_u32 s55, s51, 8192
    s_add_u32 s59, s52, 8192
    s_add_u32 s56, s51, 12288
    s_add_u32 s60, s52, 12288
    v_and_b32 v13, 15, v0
    v_lshrrev_b32 v12, 4, v0
    v_lshlrev_b32 v14, 9, v13
    v_add_u32 v8, 0, v12
    v_xor_b32 v8, v8, v13
    v_lshl_add_u32 v8, v8, 4, v14
    v_add_u32 v9, 4, v12
    v_xor_b32 v9, v9, v13
    v_lshl_add_u32 v9, v9, 4, v14
    v_add_u32 v10, 8, v12
    v_xor_b32 v10, v10, v13
    v_lshl_add_u32 v10, v10, 4, v14
    v_add_u32 v11, 12, v12
    v_xor_b32 v11, v11, v13
    v_lshl_add_u32 v11, v11, 4, v14
    v_lshlrev_b32 v14, 7, v13
    v_add_u32 v14, s72, v14
    v_lshrrev_b32 v13, 1, v13
    v_xor_b32 v13, v13, v12
    v_xor_b32 v36, 0, v13
    v_lshl_add_u32 v36, v36, 4, v14
    v_xor_b32 v37, 4, v13
    v_lshl_add_u32 v37, v37, 4, v14
    v_lshrrev_b32 v14, 2, v0
    v_and_b32 v15, 7, v14
    v_lshlrev_b32 v14, 9, v14
    v_and_b32 v13, 3, v0
    v_lshl_add_u32 v14, v13, 3, v14
    v_add_u32 v14, 98304, v14
    v_xor_b32 v16, 0, v15
    v_lshl_add_u32 v16, v16, 5, v14
    v_xor_b32 v17, 1, v15
    v_lshl_add_u32 v17, v17, 5, v14
    v_xor_b32 v18, 2, v15
    v_lshl_add_u32 v18, v18, 5, v14
    v_xor_b32 v19, 3, v15
    v_lshl_add_u32 v19, v19, 5, v14
    v_xor_b32 v20, 4, v15
    v_lshl_add_u32 v20, v20, 5, v14
    v_xor_b32 v21, 5, v15
    v_lshl_add_u32 v21, v21, 5, v14
    v_xor_b32 v22, 6, v15
    v_lshl_add_u32 v22, v22, 5, v14
    v_xor_b32 v23, 7, v15
    v_lshl_add_u32 v23, v23, 5, v14
    v_lshrrev_b32 v40, 1, v0
    v_and_b32 v41, 1, v0
    v_lshlrev_b32 v40, 9, v40
    v_lshl_add_u32 v40, v41, 7, v40
    v_and_b32 v41, 15, v0
    v_lshlrev_b32 v41, 4, v41
    v_mov_b32 v12, 0x70000000
    v_cmp_le_u32 vcc, 42, v0
    s_nop 1
    v_cndmask_b32 v35, v12, v40, vcc
    v_mov_b32 v12, 0x70000000
    v_cmp_gt_u32 vcc, 6, v0
    s_nop 1
    v_cndmask_b32 v40, v12, v40, vcc
    v_lshrrev_b32 v1, 4, v0
    v_and_b32 v12, 15, v0
    v_lshlrev_b32 v1, 9, v1
    v_lshl_add_u32 v1, v12, 4, v1
    s_mov_b32 s38, 0x3db8aa3b
    s_mov_b32 s39, 0x45800000
    s_mov_b32 s75, 0xffff0000
    v_bfe_u32 v12, v0, 2, 2
    v_lshrrev_b32 v13, 4, v0
    v_cmp_eq_u32 vcc, v12, v13
    v_and_b32 v14, 1, v0
    v_lshlrev_b32 v14, 4, v14
    v_mov_b32 v12, 15801
    v_mov_b32 v13, 47404
    v_lshlrev_b32 v12, v14, v12
    v_lshlrev_b32 v13, v14, v13
    v_cndmask_b32 v12, 0, v12, vcc
    v_cndmask_b32 v13, 0, v13, vcc
    v_and_b32 v14, 2, v0
    v_cmp_eq_u32 vcc, 0, v14
    v_mov_b32 v54, 0
    v_mov_b32 v55, 0
    v_mov_b32 v58, 0
    v_mov_b32 v59, 0
    v_mov_b32 v62, 0
    v_mov_b32 v63, 0
    v_cndmask_b32 v56, 0, v12, vcc
    v_cndmask_b32 v57, v12, 0, vcc
    v_cndmask_b32 v60, 0, v13, vcc
    v_cndmask_b32 v61, v13, 0, vcc
    s_add_u32 m0, s72, 4096
    s_xor_b32 s71, s73, 128
    buffer_load_dwordx4 v44, s[16:19], s71 offen lds
    buffer_load_dwordx4 v45, s[16:19], s71 offen offset:1024 lds
    buffer_load_dwordx4 v46, s[16:19], s71 offen offset:2048 lds
    buffer_load_dwordx4 v47, s[16:19], s71 offen offset:3072 lds
    s_waitcnt vmcnt(9)
    s_barrier
    s_add_u32 m0, s72, 8192
    s_xor_b32 s71, s73, 256
    buffer_load_dwordx4 v44, s[16:19], s71 offen lds
    buffer_load_dwordx4 v45, s[16:19], s71 offen offset:1024 lds
    buffer_load_dwordx4 v46, s[16:19], s71 offen offset:2048 lds
    buffer_load_dwordx4 v47, s[16:19], s71 offen offset:3072 lds
    s_waitcnt vmcnt(9)
    ds_read_b128 a[0:3], v36 offset:0
    ds_read_b128 a[32:35], v36 offset:2048
    ds_read_b128 a[4:7], v37 offset:0
    ds_read_b128 a[36:39], v37 offset:2048
    s_waitcnt lgkmcnt(3)
    v_mfma_f32_16x16x32_bf16 v[112:115], v[56:59], a[0:3], 0
    ds_read_b128 a[64:67], v8 offset:0
    v_mfma_f32_16x16x32_bf16 v[116:119], v[54:57], a[0:3], 0
    ds_read_b128 a[68:71], v8 offset:8192
    v_mfma_f32_16x16x32_bf16 v[112:115], v[60:63], a[0:3], v[112:115]
    ds_read_b128 a[72:75], v8 offset:16384
    v_mfma_f32_16x16x32_bf16 v[116:119], v[58:61], a[0:3], v[116:119]
    ds_read_b128 a[76:79], v8 offset:24576
    s_waitcnt lgkmcnt(6)
    v_mfma_f32_16x16x32_bf16 v[120:123], v[56:59], a[32:35], 0
    ds_read_b128 a[80:83], v9 offset:0
    v_mfma_f32_16x16x32_bf16 v[124:127], v[54:57], a[32:35], 0
    ds_read_b128 a[84:87], v9 offset:8192
    v_mfma_f32_16x16x32_bf16 v[120:123], v[60:63], a[32:35], v[120:123]
    ds_read_b128 a[88:91], v9 offset:16384
    v_mfma_f32_16x16x32_bf16 v[124:127], v[58:61], a[32:35], v[124:127]
    ds_read_b128 a[92:95], v9 offset:24576
    v_cvt_pk_bf16_f32 v112, v112, v113
    v_cvt_pk_bf16_f32 v113, v114, v115
    s_waitcnt lgkmcnt(9)
    v_mfma_f32_16x16x32_bf16 v[96:99], v[56:59], a[4:7], 0
    v_cvt_pk_bf16_f32 v114, v116, v117
    v_cvt_pk_bf16_f32 v115, v118, v119
    v_mfma_f32_16x16x32_bf16 v[100:103], v[54:57], a[4:7], 0
    v_accvgpr_write_b32 a0, v112
    v_accvgpr_write_b32 a1, v113
    v_mfma_f32_16x16x32_bf16 v[96:99], v[60:63], a[4:7], v[96:99]
    v_accvgpr_write_b32 a2, v114
    v_accvgpr_write_b32 a3, v115
    v_mfma_f32_16x16x32_bf16 v[100:103], v[58:61], a[4:7], v[100:103]
    v_cvt_pk_bf16_f32 v120, v120, v121
    v_cvt_pk_bf16_f32 v121, v122, v123
    s_waitcnt lgkmcnt(8)
    v_mfma_f32_16x16x32_bf16 v[104:107], v[56:59], a[36:39], 0
    v_cvt_pk_bf16_f32 v122, v124, v125
    v_cvt_pk_bf16_f32 v123, v126, v127
    v_mfma_f32_16x16x32_bf16 v[108:111], v[54:57], a[36:39], 0
    v_accvgpr_write_b32 a32, v120
    v_accvgpr_write_b32 a33, v121
    v_mfma_f32_16x16x32_bf16 v[104:107], v[60:63], a[36:39], v[104:107]
    v_accvgpr_write_b32 a34, v122
    v_accvgpr_write_b32 a35, v123
    v_mfma_f32_16x16x32_bf16 v[108:111], v[58:61], a[36:39], v[108:111]
    s_waitcnt lgkmcnt(7)
    v_mfma_f32_16x16x32_bf16 v[64:67], a[64:67], a[0:3], 0
    v_mfma_f32_16x16x32_bf16 v[72:75], a[64:67], a[32:35], 0
    s_waitcnt lgkmcnt(6)
    v_mfma_f32_16x16x32_bf16 v[68:71], a[68:71], a[0:3], 0
    v_cvt_pk_bf16_f32 v96, v96, v97
    v_cvt_pk_bf16_f32 v97, v98, v99
    v_mfma_f32_16x16x32_bf16 v[76:79], a[68:71], a[32:35], 0
    v_cvt_pk_bf16_f32 v98, v100, v101
    v_cvt_pk_bf16_f32 v99, v102, v103
    v_accvgpr_write_b32 a4, v96
    s_waitcnt lgkmcnt(5)
    v_mfma_f32_16x16x32_bf16 v[80:83], a[72:75], a[0:3], 0
    v_accvgpr_write_b32 a5, v97
    v_accvgpr_write_b32 a6, v98
    v_accvgpr_write_b32 a7, v99
    v_mfma_f32_16x16x32_bf16 v[88:91], a[72:75], a[32:35], 0
    v_cvt_pk_bf16_f32 v104, v104, v105
    v_cvt_pk_bf16_f32 v105, v106, v107
    s_waitcnt lgkmcnt(4)
    v_mfma_f32_16x16x32_bf16 v[84:87], a[76:79], a[0:3], 0
    v_cvt_pk_bf16_f32 v106, v108, v109
    v_cvt_pk_bf16_f32 v107, v110, v111
    v_accvgpr_write_b32 a36, v104
    v_mfma_f32_16x16x32_bf16 v[92:95], a[76:79], a[32:35], 0
    v_accvgpr_write_b32 a37, v105
    v_accvgpr_write_b32 a38, v106
    v_accvgpr_write_b32 a39, v107
    s_add_u32 m0, s72, 12288
    s_xor_b32 s71, s73, 384
    buffer_load_dwordx4 v44, s[16:19], s71 offen lds
    buffer_load_dwordx4 v45, s[16:19], s71 offen offset:1024 lds
    buffer_load_dwordx4 v46, s[16:19], s71 offen offset:2048 lds
    buffer_load_dwordx4 v47, s[16:19], s71 offen offset:3072 lds
    s_waitcnt lgkmcnt(3)
    v_mfma_f32_16x16x32_bf16 v[64:67], a[80:83], a[4:7], v[64:67]
    v_mfma_f32_16x16x32_bf16 v[72:75], a[80:83], a[36:39], v[72:75]
    s_waitcnt lgkmcnt(2)
    v_mfma_f32_16x16x32_bf16 v[68:71], a[84:87], a[4:7], v[68:71]
    v_mfma_f32_16x16x32_bf16 v[76:79], a[84:87], a[36:39], v[76:79]
    s_waitcnt lgkmcnt(1)
    v_mfma_f32_16x16x32_bf16 v[80:83], a[88:91], a[4:7], v[80:83]
    v_mfma_f32_16x16x32_bf16 v[88:91], a[88:91], a[36:39], v[88:91]
    s_waitcnt lgkmcnt(0)
    v_mfma_f32_16x16x32_bf16 v[84:87], a[92:95], a[4:7], v[84:87]
    v_mfma_f32_16x16x32_bf16 v[92:95], a[92:95], a[36:39], v[92:95]
    s_waitcnt vmcnt(8)
    ds_read_b128 a[8:11], v36 offset:4096
    ds_read_b128 a[40:43], v36 offset:6144
    ds_read_b128 a[12:15], v37 offset:4096
    ds_read_b128 a[44:47], v37 offset:6144
    s_waitcnt lgkmcnt(3)
    v_mfma_f32_16x16x32_bf16 v[112:115], v[56:59], a[8:11], 0
    ds_read_b128 a[96:99], v10 offset:0
    v_mfma_f32_16x16x32_bf16 v[116:119], v[54:57], a[8:11], 0
    ds_read_b128 a[100:103], v10 offset:8192
    v_mfma_f32_16x16x32_bf16 v[112:115], v[60:63], a[8:11], v[112:115]
    ds_read_b128 a[104:107], v10 offset:16384
    v_mfma_f32_16x16x32_bf16 v[116:119], v[58:61], a[8:11], v[116:119]
    ds_read_b128 a[108:111], v10 offset:24576
    s_waitcnt lgkmcnt(6)
    v_mfma_f32_16x16x32_bf16 v[120:123], v[56:59], a[40:43], 0
    ds_read_b128 a[112:115], v11 offset:0
    v_mfma_f32_16x16x32_bf16 v[124:127], v[54:57], a[40:43], 0
    ds_read_b128 a[116:119], v11 offset:8192
    v_mfma_f32_16x16x32_bf16 v[120:123], v[60:63], a[40:43], v[120:123]
    ds_read_b128 a[120:123], v11 offset:16384
    v_mfma_f32_16x16x32_bf16 v[124:127], v[58:61], a[40:43], v[124:127]
    ds_read_b128 a[124:127], v11 offset:24576
    v_cvt_pk_bf16_f32 v112, v112, v113
    v_cvt_pk_bf16_f32 v113, v114, v115
    s_waitcnt lgkmcnt(9)
    v_mfma_f32_16x16x32_bf16 v[96:99], v[56:59], a[12:15], 0
    v_cvt_pk_bf16_f32 v114, v116, v117
    v_cvt_pk_bf16_f32 v115, v118, v119
    v_mfma_f32_16x16x32_bf16 v[100:103], v[54:57], a[12:15], 0
    v_accvgpr_write_b32 a8, v112
    v_accvgpr_write_b32 a9, v113
    v_mfma_f32_16x16x32_bf16 v[96:99], v[60:63], a[12:15], v[96:99]
    v_accvgpr_write_b32 a10, v114
    v_accvgpr_write_b32 a11, v115
    v_mfma_f32_16x16x32_bf16 v[100:103], v[58:61], a[12:15], v[100:103]
    v_cvt_pk_bf16_f32 v120, v120, v121
    v_cvt_pk_bf16_f32 v121, v122, v123
    s_waitcnt lgkmcnt(8)
    v_mfma_f32_16x16x32_bf16 v[104:107], v[56:59], a[44:47], 0
    v_cvt_pk_bf16_f32 v122, v124, v125
    v_cvt_pk_bf16_f32 v123, v126, v127
    v_mfma_f32_16x16x32_bf16 v[108:111], v[54:57], a[44:47], 0
    v_accvgpr_write_b32 a40, v120
    v_accvgpr_write_b32 a41, v121
    v_mfma_f32_16x16x32_bf16 v[104:107], v[60:63], a[44:47], v[104:107]
    v_accvgpr_write_b32 a42, v122
    v_accvgpr_write_b32 a43, v123
    v_mfma_f32_16x16x32_bf16 v[108:111], v[58:61], a[44:47], v[108:111]
    s_waitcnt lgkmcnt(7)
    v_mfma_f32_16x16x32_bf16 v[64:67], a[96:99], a[8:11], v[64:67]
    v_mfma_f32_16x16x32_bf16 v[72:75], a[96:99], a[40:43], v[72:75]
    s_waitcnt lgkmcnt(6)
    v_mfma_f32_16x16x32_bf16 v[68:71], a[100:103], a[8:11], v[68:71]
    v_cvt_pk_bf16_f32 v96, v96, v97
    v_cvt_pk_bf16_f32 v97, v98, v99
    v_mfma_f32_16x16x32_bf16 v[76:79], a[100:103], a[40:43], v[76:79]
    v_cvt_pk_bf16_f32 v98, v100, v101
    v_cvt_pk_bf16_f32 v99, v102, v103
    v_accvgpr_write_b32 a12, v96
    s_waitcnt lgkmcnt(5)
    v_mfma_f32_16x16x32_bf16 v[80:83], a[104:107], a[8:11], v[80:83]
    v_accvgpr_write_b32 a13, v97
    v_accvgpr_write_b32 a14, v98
    v_accvgpr_write_b32 a15, v99
    v_mfma_f32_16x16x32_bf16 v[88:91], a[104:107], a[40:43], v[88:91]
    v_cvt_pk_bf16_f32 v104, v104, v105
    v_cvt_pk_bf16_f32 v105, v106, v107
    s_waitcnt lgkmcnt(4)
    v_mfma_f32_16x16x32_bf16 v[84:87], a[108:111], a[8:11], v[84:87]
    v_cvt_pk_bf16_f32 v106, v108, v109
    v_cvt_pk_bf16_f32 v107, v110, v111
    v_accvgpr_write_b32 a44, v104
    v_mfma_f32_16x16x32_bf16 v[92:95], a[108:111], a[40:43], v[92:95]
    v_accvgpr_write_b32 a45, v105
    v_accvgpr_write_b32 a46, v106
    v_accvgpr_write_b32 a47, v107
    s_pack_ll_b32_b16 m0, s36, 1
    s_nop 0
    buffer_load_dwordx4 v28, s[24:27], s36 offen nt lds
    buffer_load_dwordx4 v29, s[24:27], s36 offen offset:1024 nt lds
    buffer_load_dwordx4 v30, s[24:27], s36 offen offset:2048 nt lds
    buffer_load_dwordx4 v31, s[24:27], s36 offen offset:3072 nt lds
    s_add_u32 s36, s36, 0x4000
    s_waitcnt lgkmcnt(3)
    v_mfma_f32_16x16x32_bf16 v[64:67], a[112:115], a[12:15], v[64:67]
    v_mfma_f32_16x16x32_bf16 v[72:75], a[112:115], a[44:47], v[72:75]
    s_waitcnt lgkmcnt(2)
    v_mfma_f32_16x16x32_bf16 v[68:71], a[116:119], a[12:15], v[68:71]
    s_waitcnt vmcnt(8)
    ds_read_b128 a[16:19], v36 offset:8192
    v_mfma_f32_16x16x32_bf16 v[76:79], a[116:119], a[44:47], v[76:79]
    ds_read_b128 a[48:51], v36 offset:10240
    s_waitcnt lgkmcnt(3)
    v_mfma_f32_16x16x32_bf16 v[80:83], a[120:123], a[12:15], v[80:83]
    ds_read_b128 a[20:23], v37 offset:8192
    v_mfma_f32_16x16x32_bf16 v[88:91], a[120:123], a[44:47], v[88:91]
    ds_read_b128 a[52:55], v37 offset:10240
    s_waitcnt lgkmcnt(4)
    v_mfma_f32_16x16x32_bf16 v[84:87], a[124:127], a[12:15], v[84:87]
    v_mfma_f32_16x16x32_bf16 v[92:95], a[124:127], a[44:47], v[92:95]
    s_waitcnt lgkmcnt(3)
    v_mfma_f32_16x16x32_bf16 v[112:115], v[56:59], a[16:19], 0
    ds_read_b128 a[64:67], v8 offset:256
    v_mfma_f32_16x16x32_bf16 v[116:119], v[54:57], a[16:19], 0
    ds_read_b128 a[68:71], v8 offset:8448
    v_mfma_f32_16x16x32_bf16 v[112:115], v[60:63], a[16:19], v[112:115]
    ds_read_b128 a[72:75], v8 offset:16640
    v_mfma_f32_16x16x32_bf16 v[116:119], v[58:61], a[16:19], v[116:119]
    ds_read_b128 a[76:79], v8 offset:24832
    s_waitcnt lgkmcnt(6)
    v_mfma_f32_16x16x32_bf16 v[120:123], v[56:59], a[48:51], 0
    ds_read_b128 a[80:83], v9 offset:256
    v_mfma_f32_16x16x32_bf16 v[124:127], v[54:57], a[48:51], 0
    ds_read_b128 a[84:87], v9 offset:8448
    v_mfma_f32_16x16x32_bf16 v[120:123], v[60:63], a[48:51], v[120:123]
    ds_read_b128 a[88:91], v9 offset:16640
    v_mfma_f32_16x16x32_bf16 v[124:127], v[58:61], a[48:51], v[124:127]
    ds_read_b128 a[92:95], v9 offset:24832
    v_cvt_pk_bf16_f32 v112, v112, v113
    v_cvt_pk_bf16_f32 v113, v114, v115
    s_waitcnt lgkmcnt(9)
    v_mfma_f32_16x16x32_bf16 v[96:99], v[56:59], a[20:23], 0
    v_cvt_pk_bf16_f32 v114, v116, v117
    v_cvt_pk_bf16_f32 v115, v118, v119
    v_mfma_f32_16x16x32_bf16 v[100:103], v[54:57], a[20:23], 0
    v_accvgpr_write_b32 a16, v112
    v_accvgpr_write_b32 a17, v113
    v_mfma_f32_16x16x32_bf16 v[96:99], v[60:63], a[20:23], v[96:99]
    v_accvgpr_write_b32 a18, v114
    v_accvgpr_write_b32 a19, v115
    v_mfma_f32_16x16x32_bf16 v[100:103], v[58:61], a[20:23], v[100:103]
    v_cvt_pk_bf16_f32 v120, v120, v121
    v_cvt_pk_bf16_f32 v121, v122, v123
    s_waitcnt lgkmcnt(8)
    v_mfma_f32_16x16x32_bf16 v[104:107], v[56:59], a[52:55], 0
    v_cvt_pk_bf16_f32 v122, v124, v125
    v_cvt_pk_bf16_f32 v123, v126, v127
    v_mfma_f32_16x16x32_bf16 v[108:111], v[54:57], a[52:55], 0
    v_accvgpr_write_b32 a48, v120
    v_accvgpr_write_b32 a49, v121
    v_mfma_f32_16x16x32_bf16 v[104:107], v[60:63], a[52:55], v[104:107]
    v_accvgpr_write_b32 a50, v122
    v_accvgpr_write_b32 a51, v123
    v_mfma_f32_16x16x32_bf16 v[108:111], v[58:61], a[52:55], v[108:111]
    s_waitcnt lgkmcnt(7)
    v_mfma_f32_16x16x32_bf16 v[64:67], a[64:67], a[16:19], v[64:67]
    v_mfma_f32_16x16x32_bf16 v[72:75], a[64:67], a[48:51], v[72:75]
    s_waitcnt lgkmcnt(6)
    v_mfma_f32_16x16x32_bf16 v[68:71], a[68:71], a[16:19], v[68:71]
    v_cvt_pk_bf16_f32 v96, v96, v97
    v_cvt_pk_bf16_f32 v97, v98, v99
    v_mfma_f32_16x16x32_bf16 v[76:79], a[68:71], a[48:51], v[76:79]
    v_cvt_pk_bf16_f32 v98, v100, v101
    v_cvt_pk_bf16_f32 v99, v102, v103
    v_accvgpr_write_b32 a20, v96
    s_waitcnt lgkmcnt(5)
    v_mfma_f32_16x16x32_bf16 v[80:83], a[72:75], a[16:19], v[80:83]
    v_accvgpr_write_b32 a21, v97
    v_accvgpr_write_b32 a22, v98
    v_accvgpr_write_b32 a23, v99
    v_mfma_f32_16x16x32_bf16 v[88:91], a[72:75], a[48:51], v[88:91]
    v_cvt_pk_bf16_f32 v104, v104, v105
    v_cvt_pk_bf16_f32 v105, v106, v107
    s_waitcnt lgkmcnt(4)
    v_mfma_f32_16x16x32_bf16 v[84:87], a[76:79], a[16:19], v[84:87]
    v_cvt_pk_bf16_f32 v106, v108, v109
    v_cvt_pk_bf16_f32 v107, v110, v111
    v_accvgpr_write_b32 a52, v104
    v_mfma_f32_16x16x32_bf16 v[92:95], a[76:79], a[48:51], v[92:95]
    v_accvgpr_write_b32 a53, v105
    v_accvgpr_write_b32 a54, v106
    v_accvgpr_write_b32 a55, v107
    s_pack_ll_b32_b16 m0, s35, 0
    s_nop 0
    buffer_load_dwordx4 v24, s[20:23], s35 offen nt lds
    buffer_load_dwordx4 v25, s[20:23], s35 offen offset:1024 nt lds
    buffer_load_dwordx4 v26, s[20:23], s35 offen offset:2048 nt lds
    buffer_load_dwordx4 v27, s[20:23], s35 offen offset:3072 nt lds
    s_add_u32 s35, s35, 0x4000
    s_waitcnt lgkmcnt(3)
    v_mfma_f32_16x16x32_bf16 v[64:67], a[80:83], a[20:23], v[64:67]
    v_mfma_f32_16x16x32_bf16 v[72:75], a[80:83], a[52:55], v[72:75]
    s_waitcnt lgkmcnt(2)
    v_mfma_f32_16x16x32_bf16 v[68:71], a[84:87], a[20:23], v[68:71]
    s_waitcnt vmcnt(8)
    ds_read_b128 a[24:27], v36 offset:12288
    v_mfma_f32_16x16x32_bf16 v[76:79], a[84:87], a[52:55], v[76:79]
    ds_read_b128 a[56:59], v36 offset:14336
    s_waitcnt lgkmcnt(3)
    v_mfma_f32_16x16x32_bf16 v[80:83], a[88:91], a[20:23], v[80:83]
    ds_read_b128 a[28:31], v37 offset:12288
    v_mfma_f32_16x16x32_bf16 v[88:91], a[88:91], a[52:55], v[88:91]
    ds_read_b128 a[60:63], v37 offset:14336
    s_waitcnt lgkmcnt(4)
    v_mfma_f32_16x16x32_bf16 v[84:87], a[92:95], a[20:23], v[84:87]
    v_mfma_f32_16x16x32_bf16 v[92:95], a[92:95], a[52:55], v[92:95]
    s_waitcnt lgkmcnt(3)
    v_mfma_f32_16x16x32_bf16 v[112:115], v[56:59], a[24:27], 0
    ds_read_b128 a[96:99], v10 offset:256
    v_mfma_f32_16x16x32_bf16 v[116:119], v[54:57], a[24:27], 0
    ds_read_b128 a[100:103], v10 offset:8448
    v_mfma_f32_16x16x32_bf16 v[112:115], v[60:63], a[24:27], v[112:115]
    ds_read_b128 a[104:107], v10 offset:16640
    v_mfma_f32_16x16x32_bf16 v[116:119], v[58:61], a[24:27], v[116:119]
    ds_read_b128 a[108:111], v10 offset:24832
    s_waitcnt lgkmcnt(6)
    v_mfma_f32_16x16x32_bf16 v[120:123], v[56:59], a[56:59], 0
    ds_read_b128 a[112:115], v11 offset:256
    v_mfma_f32_16x16x32_bf16 v[124:127], v[54:57], a[56:59], 0
    ds_read_b128 a[116:119], v11 offset:8448
    v_mfma_f32_16x16x32_bf16 v[120:123], v[60:63], a[56:59], v[120:123]
    ds_read_b128 a[120:123], v11 offset:16640
    v_mfma_f32_16x16x32_bf16 v[124:127], v[58:61], a[56:59], v[124:127]
    ds_read_b128 a[124:127], v11 offset:24832
    v_cvt_pk_bf16_f32 v112, v112, v113
    v_cvt_pk_bf16_f32 v113, v114, v115
    s_waitcnt lgkmcnt(9)
    v_mfma_f32_16x16x32_bf16 v[96:99], v[56:59], a[28:31], 0
    v_cvt_pk_bf16_f32 v114, v116, v117
    v_cvt_pk_bf16_f32 v115, v118, v119
    v_mfma_f32_16x16x32_bf16 v[100:103], v[54:57], a[28:31], 0
    v_accvgpr_write_b32 a24, v112
    v_accvgpr_write_b32 a25, v113
    v_mfma_f32_16x16x32_bf16 v[96:99], v[60:63], a[28:31], v[96:99]
    v_accvgpr_write_b32 a26, v114
    v_accvgpr_write_b32 a27, v115
    v_mfma_f32_16x16x32_bf16 v[100:103], v[58:61], a[28:31], v[100:103]
    v_cvt_pk_bf16_f32 v120, v120, v121
    v_cvt_pk_bf16_f32 v121, v122, v123
    s_waitcnt lgkmcnt(8)
    v_mfma_f32_16x16x32_bf16 v[104:107], v[56:59], a[60:63], 0
    v_cvt_pk_bf16_f32 v122, v124, v125
    v_cvt_pk_bf16_f32 v123, v126, v127
    v_mfma_f32_16x16x32_bf16 v[108:111], v[54:57], a[60:63], 0
    v_accvgpr_write_b32 a56, v120
    v_accvgpr_write_b32 a57, v121
    v_mfma_f32_16x16x32_bf16 v[104:107], v[60:63], a[60:63], v[104:107]
    v_accvgpr_write_b32 a58, v122
    v_accvgpr_write_b32 a59, v123
    v_mfma_f32_16x16x32_bf16 v[108:111], v[58:61], a[60:63], v[108:111]
    s_waitcnt lgkmcnt(7)
    v_mfma_f32_16x16x32_bf16 v[64:67], a[96:99], a[24:27], v[64:67]
    v_mfma_f32_16x16x32_bf16 v[72:75], a[96:99], a[56:59], v[72:75]
    s_waitcnt lgkmcnt(6)
    v_mfma_f32_16x16x32_bf16 v[68:71], a[100:103], a[24:27], v[68:71]
    v_cvt_pk_bf16_f32 v96, v96, v97
    v_cvt_pk_bf16_f32 v97, v98, v99
    v_mfma_f32_16x16x32_bf16 v[76:79], a[100:103], a[56:59], v[76:79]
    v_cvt_pk_bf16_f32 v98, v100, v101
    v_cvt_pk_bf16_f32 v99, v102, v103
    v_accvgpr_write_b32 a28, v96
    s_waitcnt lgkmcnt(5)
    v_mfma_f32_16x16x32_bf16 v[80:83], a[104:107], a[24:27], v[80:83]
    v_accvgpr_write_b32 a29, v97
    v_accvgpr_write_b32 a30, v98
    v_accvgpr_write_b32 a31, v99
    v_mfma_f32_16x16x32_bf16 v[88:91], a[104:107], a[56:59], v[88:91]
    v_cvt_pk_bf16_f32 v104, v104, v105
    v_cvt_pk_bf16_f32 v105, v106, v107
    s_waitcnt lgkmcnt(4)
    v_mfma_f32_16x16x32_bf16 v[84:87], a[108:111], a[24:27], v[84:87]
    v_cvt_pk_bf16_f32 v106, v108, v109
    v_cvt_pk_bf16_f32 v107, v110, v111
    v_accvgpr_write_b32 a60, v104
    v_mfma_f32_16x16x32_bf16 v[92:95], a[108:111], a[56:59], v[92:95]
    v_accvgpr_write_b32 a61, v105
    v_accvgpr_write_b32 a62, v106
    v_accvgpr_write_b32 a63, v107
    s_nop 1
    s_waitcnt lgkmcnt(3)
    v_mfma_f32_16x16x32_bf16 v[64:67], a[112:115], a[28:31], v[64:67]
    v_mfma_f32_16x16x32_bf16 v[72:75], a[112:115], a[60:63], v[72:75]
    s_waitcnt lgkmcnt(2)
    v_mfma_f32_16x16x32_bf16 v[68:71], a[116:119], a[28:31], v[68:71]
    v_mfma_f32_16x16x32_bf16 v[76:79], a[116:119], a[60:63], v[76:79]
    s_waitcnt lgkmcnt(1)
    v_mfma_f32_16x16x32_bf16 v[80:83], a[120:123], a[28:31], v[80:83]
    v_mfma_f32_16x16x32_bf16 v[88:91], a[120:123], a[60:63], v[88:91]
    s_waitcnt lgkmcnt(0)
    v_mfma_f32_16x16x32_bf16 v[84:87], a[124:127], a[28:31], v[84:87]
    s_nop 4
    v_mfma_f32_16x16x32_bf16 v[92:95], a[124:127], a[60:63], v[92:95]
    v_max3_f32 v12, v64, v65, v66
    v_max3_f32 v14, v72, v73, v74
    v_max3_f32 v12, v12, v67, v68
    v_max3_f32 v14, v14, v75, v76
    v_max3_f32 v12, v12, v69, v70
    v_max3_f32 v14, v14, v77, v78
    v_max_f32 v12, v12, v71
    v_max_f32 v14, v14, v79
    v_mov_b32 v13, v12
    v_mov_b32 v15, v14
    s_nop 0
    v_permlane16_swap_b32 v12, v13
    v_permlane16_swap_b32 v14, v15
    v_max_f32 v12, v12, v13
    v_max_f32 v14, v14, v15
    v_mov_b32 v13, v12
    v_mov_b32 v15, v14
    s_nop 0
    v_permlane32_swap_b32 v12, v13
    v_permlane32_swap_b32 v14, v15
    v_max_f32 v12, v12, v13
    v_max_f32 v14, v14, v15
    v_sub_f32 v2, 0, v12
    v_sub_f32 v3, 0, v14
    v_add_f32 v64, v64, v2
    v_add_f32 v65, v65, v2
    v_add_f32 v66, v66, v2
    v_add_f32 v67, v67, v2
    v_add_f32 v72, v72, v3
    v_add_f32 v73, v73, v3
    v_add_f32 v74, v74, v3
    v_add_f32 v75, v75, v3
    v_add_f32 v68, v68, v2
    v_add_f32 v69, v69, v2
    v_add_f32 v70, v70, v2
    v_add_f32 v71, v71, v2
    v_add_f32 v76, v76, v3
    v_add_f32 v77, v77, v3
    v_add_f32 v78, v78, v3
    v_add_f32 v79, v79, v3
    v_exp_f32 v112, v64
    v_exp_f32 v113, v65
    v_exp_f32 v114, v66
    v_exp_f32 v115, v67
    v_add_f32 v6, v112, v113
    v_cvt_pk_bf16_f32 v96, v112, v113
    v_exp_f32 v120, v72
    v_add_f32 v6, v6, v114
    v_exp_f32 v121, v73
    v_add_f32 v6, v6, v115
    v_cvt_pk_bf16_f32 v97, v114, v115
    v_exp_f32 v122, v74
    v_exp_f32 v123, v75
    v_add_f32 v7, v120, v121
    v_cvt_pk_bf16_f32 v100, v120, v121
    v_exp_f32 v116, v68
    v_add_f32 v7, v7, v122
    v_exp_f32 v117, v69
    v_add_f32 v7, v7, v123
    v_cvt_pk_bf16_f32 v101, v122, v123
    v_exp_f32 v118, v70
    v_add_f32 v6, v6, v116
    v_exp_f32 v119, v71
    v_add_f32 v6, v6, v117
    v_cvt_pk_bf16_f32 v98, v116, v117
    s_pack_ll_b32_b16 m0, s36, 1
    s_nop 0
    buffer_load_dwordx4 v28, s[24:27], s36 offen nt lds
    buffer_load_dwordx4 v29, s[24:27], s36 offen offset:1024 nt lds
    buffer_load_dwordx4 v30, s[24:27], s36 offen offset:2048 nt lds
    buffer_load_dwordx4 v31, s[24:27], s36 offen offset:3072 nt lds
    s_add_u32 s36, s36, 0x4000
    s_waitcnt vmcnt(8)
    s_barrier
    ds_read_b64_tr_b16 a[96:97], v16 offset:16384
    ds_read_b64_tr_b16 a[98:99], v16 offset:24576
    ds_read_b64_tr_b16 a[100:101], v17 offset:16384
    ds_read_b64_tr_b16 a[102:103], v17 offset:24576
    ds_read_b64_tr_b16 a[104:105], v18 offset:16384
    ds_read_b64_tr_b16 a[106:107], v18 offset:24576
    ds_read_b64_tr_b16 a[108:109], v19 offset:16384
    ds_read_b64_tr_b16 a[110:111], v19 offset:24576
    ds_read_b64_tr_b16 a[112:113], v20 offset:16384
    ds_read_b64_tr_b16 a[114:115], v20 offset:24576
    ds_read_b64_tr_b16 a[116:117], v21 offset:16384
    ds_read_b64_tr_b16 a[118:119], v21 offset:24576
    v_exp_f32 v124, v76
    v_add_f32 v6, v6, v118
    v_exp_f32 v125, v77
    v_add_f32 v6, v6, v119
    v_cvt_pk_bf16_f32 v99, v118, v119
    v_exp_f32 v126, v78
    v_add_f32 v7, v7, v124
    v_exp_f32 v127, v79
    v_add_f32 v7, v7, v125
    v_cvt_pk_bf16_f32 v102, v124, v125
    v_add_f32 v7, v7, v126
    v_add_f32 v7, v7, v127
    v_cvt_pk_bf16_f32 v103, v126, v127
    s_nop 0
    s_waitcnt lgkmcnt(10)
    v_mfma_f32_16x16x32_bf16 v[128:131], a[96:99], v[96:99], 0
    ds_read_b64_tr_b16 a[120:121], v22 offset:16384
    s_pack_ll_b32_b16 m0, s35, 0
    v_mov_b32 v4, v6
    v_mfma_f32_16x16x32_bf16 v[132:135], a[96:99], v[100:103], 0
    ds_read_b64_tr_b16 a[122:123], v22 offset:24576
    v_xor_b32 v8, 0x8000, v8
    v_mov_b32 v5, v7
    s_waitcnt lgkmcnt(10)
    v_mfma_f32_16x16x32_bf16 v[136:139], a[100:103], v[96:99], 0
    ds_read_b64_tr_b16 a[124:125], v23 offset:16384
    v_mov_b32 v48, v2
    v_mov_b32 v49, v2
    v_mfma_f32_16x16x32_bf16 v[140:143], a[100:103], v[100:103], 0
    ds_read_b64_tr_b16 a[126:127], v23 offset:24576
    buffer_load_dwordx4 v24, s[20:23], s35 offen nt lds
    v_mov_b32 v50, v2
    s_waitcnt lgkmcnt(10)
    v_mfma_f32_16x16x32_bf16 v[144:147], a[104:107], v[96:99], 0
    ds_read_b64_tr_b16 a[96:97], v16 offset:16640
    v_mov_b32 v51, v2
    v_mov_b32 v52, v3
    v_mfma_f32_16x16x32_bf16 v[148:151], a[104:107], v[100:103], 0
    ds_read_b64_tr_b16 a[98:99], v16 offset:24832
    v_xor_b32 v9, 0x8000, v9
    v_mov_b32 v53, v3
    v_mov_b32 v54, v3
    s_waitcnt lgkmcnt(10)
    v_mfma_f32_16x16x32_bf16 v[152:155], a[108:111], v[96:99], 0
    ds_read_b64_tr_b16 a[100:101], v17 offset:16640
    buffer_load_dwordx4 v25, s[20:23], s35 offen offset:1024 nt lds
    v_mov_b32 v55, v3
    v_add_f32 v80, v80, v2
    v_mfma_f32_16x16x32_bf16 v[156:159], a[108:111], v[100:103], 0
    ds_read_b64_tr_b16 a[102:103], v17 offset:24832
    v_add_f32 v81, v81, v2
    v_add_f32 v82, v82, v2
    s_waitcnt lgkmcnt(10)
    v_mfma_f32_16x16x32_bf16 v[160:163], a[112:115], v[96:99], 0
    ds_read_b64_tr_b16 a[104:105], v18 offset:16640
    v_add_f32 v83, v83, v2
    v_add_f32 v88, v88, v3
    v_add_f32 v89, v89, v3
    v_mfma_f32_16x16x32_bf16 v[164:167], a[112:115], v[100:103], 0
    ds_read_b64_tr_b16 a[106:107], v18 offset:24832
    v_add_f32 v90, v90, v3
    v_add_f32 v91, v91, v3
    v_add_f32 v84, v84, v2
    s_waitcnt lgkmcnt(10)
    v_mfma_f32_16x16x32_bf16 v[168:171], a[116:119], v[96:99], 0
    ds_read_b64_tr_b16 a[108:109], v19 offset:16640
    buffer_load_dwordx4 v26, s[20:23], s35 offen offset:2048 nt lds
    v_add_f32 v85, v85, v2
    v_add_f32 v86, v86, v2
    v_mfma_f32_16x16x32_bf16 v[172:175], a[116:119], v[100:103], 0
    ds_read_b64_tr_b16 a[110:111], v19 offset:24832
    v_xor_b32 v10, 0x8000, v10
    v_add_f32 v87, v87, v2
    v_add_f32 v92, v92, v3
    s_waitcnt lgkmcnt(10)
    v_mfma_f32_16x16x32_bf16 v[176:179], a[120:123], v[96:99], 0
    ds_read_b64_tr_b16 a[112:113], v20 offset:16640
    v_add_f32 v93, v93, v3
    v_add_f32 v94, v94, v3
    v_add_f32 v95, v95, v3
    v_mfma_f32_16x16x32_bf16 v[180:183], a[120:123], v[100:103], 0
    ds_read_b64_tr_b16 a[114:115], v20 offset:24832
    buffer_load_dwordx4 v27, s[20:23], s35 offen offset:3072 nt lds
    v_exp_f32 v112, v80
    s_waitcnt lgkmcnt(10)
    v_mfma_f32_16x16x32_bf16 v[184:187], a[124:127], v[96:99], 0
    ds_read_b64_tr_b16 a[116:117], v21 offset:16640
    v_exp_f32 v113, v81
    v_mfma_f32_16x16x32_bf16 v[188:191], a[124:127], v[100:103], 0
    ds_read_b64_tr_b16 a[118:119], v21 offset:24832
    v_xor_b32 v11, 0x8000, v11
    s_waitcnt lgkmcnt(10)
    v_mfma_f32_16x16x32_bf16 v[192:195], a[96:99], v[96:99], 0
    ds_read_b64_tr_b16 a[120:121], v22 offset:16640
    s_add_u32 s35, s35, 0x4000
    v_exp_f32 v114, v82
    v_mfma_f32_16x16x32_bf16 v[196:199], a[96:99], v[100:103], 0
    ds_read_b64_tr_b16 a[122:123], v22 offset:24832
    v_exp_f32 v115, v83
    v_add_f32 v6, v112, v113
    s_waitcnt lgkmcnt(10)
    v_mfma_f32_16x16x32_bf16 v[200:203], a[100:103], v[96:99], 0
    ds_read_b64_tr_b16 a[124:125], v23 offset:16640
    v_cvt_pk_bf16_f32 v104, v112, v113
    v_exp_f32 v120, v88
    v_mfma_f32_16x16x32_bf16 v[204:207], a[100:103], v[100:103], 0
    ds_read_b64_tr_b16 a[126:127], v23 offset:24832
    v_add_f32 v6, v6, v114
    v_exp_f32 v121, v89
    s_waitcnt lgkmcnt(10)
    v_mfma_f32_16x16x32_bf16 v[208:211], a[104:107], v[96:99], 0
    s_waitcnt vmcnt(8)
    s_barrier
    ds_read_b128 a[64:67], v8 offset:0
    v_mfma_f32_16x16x32_bf16 v[212:215], a[104:107], v[100:103], 0
    v_add_f32 v6, v6, v115
    v_cvt_pk_bf16_f32 v105, v114, v115
    v_exp_f32 v122, v90
    s_waitcnt lgkmcnt(9)
    v_mfma_f32_16x16x32_bf16 v[216:219], a[108:111], v[96:99], 0
    ds_read_b128 a[68:71], v9 offset:0
    v_exp_f32 v123, v91
    v_mfma_f32_16x16x32_bf16 v[220:223], a[108:111], v[100:103], 0
    v_add_f32 v7, v120, v121
    v_cvt_pk_bf16_f32 v108, v120, v121
    s_waitcnt lgkmcnt(8)
    v_mfma_f32_16x16x32_bf16 v[224:227], a[112:115], v[96:99], 0
    ds_read_b128 a[72:75], v10 offset:0
    v_exp_f32 v116, v84
    v_add_f32 v7, v7, v122
    v_mfma_f32_16x16x32_bf16 v[228:231], a[112:115], v[100:103], 0
    v_exp_f32 v117, v85
    v_add_f32 v7, v7, v123
    v_cvt_pk_bf16_f32 v109, v122, v123
    s_waitcnt lgkmcnt(7)
    v_mfma_f32_16x16x32_bf16 v[232:235], a[116:119], v[96:99], 0
    ds_read_b128 a[76:79], v11 offset:0
    v_exp_f32 v118, v86
    v_add_f32 v6, v6, v116
    v_mfma_f32_16x16x32_bf16 v[236:239], a[116:119], v[100:103], 0
    v_exp_f32 v119, v87
    v_add_f32 v6, v6, v117
    v_cvt_pk_bf16_f32 v106, v116, v117
    s_waitcnt lgkmcnt(6)
    v_mfma_f32_16x16x32_bf16 v[240:243], a[120:123], v[96:99], 0
    ds_read_b128 a[80:83], v8 offset:256
    v_exp_f32 v124, v92
    v_add_f32 v6, v6, v118
    v_mfma_f32_16x16x32_bf16 v[244:247], a[120:123], v[100:103], 0
    v_exp_f32 v125, v93
    v_add_f32 v6, v6, v119
    v_cvt_pk_bf16_f32 v107, v118, v119
    s_waitcnt lgkmcnt(5)
    v_mfma_f32_16x16x32_bf16 v[248:251], a[124:127], v[96:99], 0
    ds_read_b128 a[84:87], v9 offset:256
    v_exp_f32 v126, v94
    v_add_f32 v7, v7, v124
    v_mfma_f32_16x16x32_bf16 v[252:255], a[124:127], v[100:103], 0
    buffer_load_dwordx4 a[128:131], off, s[12:15], s45 sc1
    buffer_load_dword a133, v41, s[12:15], s47 offen
    s_mov_b32 s37, 7
L_loopA:
    s_waitcnt lgkmcnt(5)
    v_mfma_f32_16x16x32_bf16 v[64:67], a[64:67], a[0:3], 0
    ds_read_b128 a[88:91], v10 offset:256
    v_xor_b32 v16, 0x8000, v16
    v_mfma_f32_16x16x32_bf16 v[72:75], a[64:67], a[32:35], 0
    s_pack_ll_b32_b16 m0, s36, 1
    v_exp_f32 v127, v95
    s_waitcnt lgkmcnt(5)
    v_mfma_f32_16x16x32_bf16 v[64:67], a[68:71], a[4:7], v[64:67]
    ds_read_b128 a[92:95], v11 offset:256
    v_xor_b32 v17, 0x8000, v17
    v_mfma_f32_16x16x32_bf16 v[72:75], a[68:71], a[36:39], v[72:75]
    buffer_load_dwordx4 v28, s[24:27], s36 offen nt lds
    v_add_f32 v7, v7, v125
    s_waitcnt lgkmcnt(5)
    v_mfma_f32_16x16x32_bf16 v[64:67], a[72:75], a[8:11], v[64:67]
    ds_read_b128 a[64:67], v8 offset:8192
    v_cvt_pk_bf16_f32 v110, v124, v125
    v_mfma_f32_16x16x32_bf16 v[72:75], a[72:75], a[40:43], v[72:75]
    v_xor_b32 v18, 0x8000, v18
    v_add_f32 v7, v7, v126
    s_waitcnt lgkmcnt(5)
    v_mfma_f32_16x16x32_bf16 v[64:67], a[76:79], a[12:15], v[64:67]
    ds_read_b128 a[68:71], v9 offset:8192
    buffer_load_dwordx4 v29, s[24:27], s36 offen offset:1024 nt lds
    v_mfma_f32_16x16x32_bf16 v[72:75], a[76:79], a[44:47], v[72:75]
    v_xor_b32 v19, 0x8000, v19
    s_waitcnt lgkmcnt(5)
    v_mfma_f32_16x16x32_bf16 v[64:67], a[80:83], a[16:19], v[64:67]
    ds_read_b128 a[72:75], v10 offset:8192
    v_add_f32 v7, v7, v127
    v_mfma_f32_16x16x32_bf16 v[72:75], a[80:83], a[48:51], v[72:75]
    v_cvt_pk_bf16_f32 v111, v126, v127
    v_add_f32 v12, v6, v7
    s_waitcnt lgkmcnt(5)
    v_mfma_f32_16x16x32_bf16 v[64:67], a[84:87], a[20:23], v[64:67]
    ds_read_b128 a[76:79], v11 offset:8192
    v_xor_b32 v20, 0x8000, v20
    v_mfma_f32_16x16x32_bf16 v[72:75], a[84:87], a[52:55], v[72:75]
    buffer_load_dwordx4 v30, s[24:27], s36 offen offset:2048 nt lds
    v_cmp_nge_f32 vcc, s39, v12
    s_waitcnt lgkmcnt(5)
    v_mfma_f32_16x16x32_bf16 v[64:67], a[88:91], a[24:27], v[64:67]
    ds_read_b128 a[80:83], v8 offset:8448
    v_xor_b32 v21, 0x8000, v21
    v_mfma_f32_16x16x32_bf16 v[72:75], a[88:91], a[56:59], v[72:75]
    buffer_load_dwordx4 v31, s[24:27], s36 offen offset:3072 nt lds
    s_cbranch_vccnz L_rare0
L_back0:
    s_waitcnt lgkmcnt(5)
    v_mfma_f32_16x16x32_bf16 v[64:67], a[92:95], a[28:31], v[64:67]
    ds_read_b128 a[84:87], v9 offset:8448
    v_add_f32 v4, v4, v6
    v_mfma_f32_16x16x32_bf16 v[72:75], a[92:95], a[60:63], v[72:75]
    v_xor_b32 v22, 0x8000, v22
    s_waitcnt lgkmcnt(5)
    v_mfma_f32_16x16x32_bf16 v[68:71], a[64:67], a[0:3], 0
    ds_read_b128 a[88:91], v10 offset:8448
    v_add_f32 v5, v5, v7
    v_mfma_f32_16x16x32_bf16 v[76:79], a[64:67], a[32:35], 0
    s_add_u32 s36, s36, 0x4000
    v_xor_b32 v23, 0x8000, v23
    s_waitcnt lgkmcnt(5)
    v_mfma_f32_16x16x32_bf16 v[68:71], a[68:71], a[4:7], v[68:71]
    ds_read_b128 a[92:95], v11 offset:8448
    v_add_f32 v64, v64, v2
    v_add_f32 v65, v65, v2
    v_mfma_f32_16x16x32_bf16 v[76:79], a[68:71], a[36:39], v[76:79]
    v_exp_f32 v112, v64
    v_add_f32 v66, v66, v2
    s_waitcnt lgkmcnt(5)
    v_mfma_f32_16x16x32_bf16 v[68:71], a[72:75], a[8:11], v[68:71]
    s_waitcnt vmcnt(10)
    s_barrier
    ds_read_b64_tr_b16 a[96:97], v16 offset:0
    v_mfma_f32_16x16x32_bf16 v[76:79], a[72:75], a[40:43], v[76:79]
    ds_read_b64_tr_b16 a[98:99], v16 offset:8192
    v_exp_f32 v113, v65
    s_waitcnt lgkmcnt(6)
    v_mfma_f32_16x16x32_bf16 v[68:71], a[76:79], a[12:15], v[68:71]
    ds_read_b64_tr_b16 a[100:101], v17 offset:0
    v_add_f32 v67, v67, v2
    v_exp_f32 v114, v66
    v_mfma_f32_16x16x32_bf16 v[76:79], a[76:79], a[44:47], v[76:79]
    ds_read_b64_tr_b16 a[102:103], v17 offset:8192
    v_add_f32 v72, v72, v3
    s_waitcnt lgkmcnt(7)
    v_mfma_f32_16x16x32_bf16 v[68:71], a[80:83], a[16:19], v[68:71]
    ds_read_b64_tr_b16 a[104:105], v18 offset:0
    v_exp_f32 v115, v67
    v_mfma_f32_16x16x32_bf16 v[76:79], a[80:83], a[48:51], v[76:79]
    ds_read_b64_tr_b16 a[106:107], v18 offset:8192
    v_add_f32 v6, v112, v113
    s_waitcnt lgkmcnt(8)
    v_mfma_f32_16x16x32_bf16 v[68:71], a[84:87], a[20:23], v[68:71]
    ds_read_b64_tr_b16 a[108:109], v19 offset:0
    v_cvt_pk_bf16_f32 v96, v112, v113
    v_add_f32 v73, v73, v3
    v_mfma_f32_16x16x32_bf16 v[76:79], a[84:87], a[52:55], v[76:79]
    ds_read_b64_tr_b16 a[110:111], v19 offset:8192
    v_exp_f32 v120, v72
    s_waitcnt lgkmcnt(9)
    v_mfma_f32_16x16x32_bf16 v[68:71], a[88:91], a[24:27], v[68:71]
    ds_read_b64_tr_b16 a[112:113], v20 offset:0
    v_add_f32 v6, v6, v114
    v_mfma_f32_16x16x32_bf16 v[76:79], a[88:91], a[56:59], v[76:79]
    ds_read_b64_tr_b16 a[114:115], v20 offset:8192
    v_exp_f32 v121, v73
    s_waitcnt lgkmcnt(10)
    v_mfma_f32_16x16x32_bf16 v[68:71], a[92:95], a[28:31], v[68:71]
    ds_read_b64_tr_b16 a[116:117], v21 offset:0
    v_add_f32 v6, v6, v115
    v_mfma_f32_16x16x32_bf16 v[76:79], a[92:95], a[60:63], v[76:79]
    ds_read_b64_tr_b16 a[118:119], v21 offset:8192
    v_cvt_pk_bf16_f32 v97, v114, v115
    s_waitcnt lgkmcnt(10)
    v_mfma_f32_16x16x32_bf16 v[128:131], a[96:99], v[104:107], v[128:131]
    ds_read_b64_tr_b16 a[120:121], v22 offset:0
    s_pack_ll_b32_b16 m0, s35, 0
    v_mfma_f32_16x16x32_bf16 v[132:135], a[96:99], v[108:111], v[132:135]
    ds_read_b64_tr_b16 a[122:123], v22 offset:8192
    v_add_f32 v74, v74, v3
    s_waitcnt lgkmcnt(10)
    v_mfma_f32_16x16x32_bf16 v[136:139], a[100:103], v[104:107], v[136:139]
    ds_read_b64_tr_b16 a[124:125], v23 offset:0
    v_add_f32 v75, v75, v3
    v_mfma_f32_16x16x32_bf16 v[140:143], a[100:103], v[108:111], v[140:143]
    ds_read_b64_tr_b16 a[126:127], v23 offset:8192
    buffer_load_dwordx4 v24, s[20:23], s35 offen nt lds
    s_waitcnt lgkmcnt(10)
    v_mfma_f32_16x16x32_bf16 v[144:147], a[104:107], v[104:107], v[144:147]
    ds_read_b64_tr_b16 a[96:97], v16 offset:256
    v_exp_f32 v122, v74
    v_mfma_f32_16x16x32_bf16 v[148:151], a[104:107], v[108:111], v[148:151]
    ds_read_b64_tr_b16 a[98:99], v16 offset:8448
    v_add_f32 v68, v68, v2
    s_waitcnt lgkmcnt(10)
    v_mfma_f32_16x16x32_bf16 v[152:155], a[108:111], v[104:107], v[152:155]
    ds_read_b64_tr_b16 a[100:101], v17 offset:256
    buffer_load_dwordx4 v25, s[20:23], s35 offen offset:1024 nt lds
    v_mfma_f32_16x16x32_bf16 v[156:159], a[108:111], v[108:111], v[156:159]
    ds_read_b64_tr_b16 a[102:103], v17 offset:8448
    s_waitcnt lgkmcnt(10)
    v_mfma_f32_16x16x32_bf16 v[160:163], a[112:115], v[104:107], v[160:163]
    ds_read_b64_tr_b16 a[104:105], v18 offset:256
    v_exp_f32 v123, v75
    v_mfma_f32_16x16x32_bf16 v[164:167], a[112:115], v[108:111], v[164:167]
    ds_read_b64_tr_b16 a[106:107], v18 offset:8448
    v_add_f32 v7, v120, v121
    s_waitcnt lgkmcnt(10)
    v_mfma_f32_16x16x32_bf16 v[168:171], a[116:119], v[104:107], v[168:171]
    ds_read_b64_tr_b16 a[108:109], v19 offset:256
    buffer_load_dwordx4 v26, s[20:23], s35 offen offset:2048 nt lds
    v_mfma_f32_16x16x32_bf16 v[172:175], a[116:119], v[108:111], v[172:175]
    ds_read_b64_tr_b16 a[110:111], v19 offset:8448
    v_cvt_pk_bf16_f32 v100, v120, v121
    s_waitcnt lgkmcnt(10)
    v_mfma_f32_16x16x32_bf16 v[176:179], a[120:123], v[104:107], v[176:179]
    ds_read_b64_tr_b16 a[112:113], v20 offset:256
    v_add_f32 v69, v69, v2
    v_mfma_f32_16x16x32_bf16 v[180:183], a[120:123], v[108:111], v[180:183]
    ds_read_b64_tr_b16 a[114:115], v20 offset:8448
    buffer_load_dwordx4 v27, s[20:23], s35 offen offset:3072 nt lds
    s_waitcnt lgkmcnt(10)
    v_mfma_f32_16x16x32_bf16 v[184:187], a[124:127], v[104:107], v[184:187]
    ds_read_b64_tr_b16 a[116:117], v21 offset:256
    v_exp_f32 v116, v68
    v_mfma_f32_16x16x32_bf16 v[188:191], a[124:127], v[108:111], v[188:191]
    ds_read_b64_tr_b16 a[118:119], v21 offset:8448
    s_waitcnt lgkmcnt(10)
    v_mfma_f32_16x16x32_bf16 v[192:195], a[96:99], v[104:107], v[192:195]
    ds_read_b64_tr_b16 a[120:121], v22 offset:256
    s_add_u32 s35, s35, 0x4000
    v_mfma_f32_16x16x32_bf16 v[196:199], a[96:99], v[108:111], v[196:199]
    ds_read_b64_tr_b16 a[122:123], v22 offset:8448
    v_add_f32 v7, v7, v122
    s_waitcnt lgkmcnt(10)
    v_mfma_f32_16x16x32_bf16 v[200:203], a[100:103], v[104:107], v[200:203]
    ds_read_b64_tr_b16 a[124:125], v23 offset:256
    v_add_f32 v70, v70, v2
    v_mfma_f32_16x16x32_bf16 v[204:207], a[100:103], v[108:111], v[204:207]
    ds_read_b64_tr_b16 a[126:127], v23 offset:8448
    v_exp_f32 v117, v69
    s_waitcnt lgkmcnt(10)
    v_mfma_f32_16x16x32_bf16 v[208:211], a[104:107], v[104:107], v[208:211]
    s_waitcnt vmcnt(10)
    s_barrier
    ds_read_b128 a[64:67], v8 offset:16384
    v_mfma_f32_16x16x32_bf16 v[212:215], a[104:107], v[108:111], v[212:215]
    v_add_f32 v7, v7, v123
    v_cvt_pk_bf16_f32 v101, v122, v123
    v_add_f32 v71, v71, v2
    s_waitcnt lgkmcnt(9)
    v_mfma_f32_16x16x32_bf16 v[216:219], a[108:111], v[104:107], v[216:219]
    ds_read_b128 a[68:71], v9 offset:16384
    v_exp_f32 v118, v70
    v_mfma_f32_16x16x32_bf16 v[220:223], a[108:111], v[108:111], v[220:223]
    v_add_f32 v6, v6, v116
    v_add_f32 v76, v76, v3
    s_waitcnt lgkmcnt(8)
    v_mfma_f32_16x16x32_bf16 v[224:227], a[112:115], v[104:107], v[224:227]
    ds_read_b128 a[72:75], v10 offset:16384
    v_exp_f32 v119, v71
    v_mfma_f32_16x16x32_bf16 v[228:231], a[112:115], v[108:111], v[228:231]
    v_add_f32 v6, v6, v117
    v_cvt_pk_bf16_f32 v98, v116, v117
    v_add_f32 v77, v77, v3
    s_waitcnt lgkmcnt(7)
    v_mfma_f32_16x16x32_bf16 v[232:235], a[116:119], v[104:107], v[232:235]
    ds_read_b128 a[76:79], v11 offset:16384
    v_exp_f32 v124, v76
    v_mfma_f32_16x16x32_bf16 v[236:239], a[116:119], v[108:111], v[236:239]
    v_add_f32 v6, v6, v118
    v_add_f32 v78, v78, v3
    s_waitcnt lgkmcnt(6)
    v_mfma_f32_16x16x32_bf16 v[240:243], a[120:123], v[104:107], v[240:243]
    ds_read_b128 a[80:83], v8 offset:16640
    v_exp_f32 v125, v77
    v_mfma_f32_16x16x32_bf16 v[244:247], a[120:123], v[108:111], v[244:247]
    v_add_f32 v6, v6, v119
    v_cvt_pk_bf16_f32 v99, v118, v119
    v_add_f32 v79, v79, v3
    s_waitcnt lgkmcnt(5)
    v_mfma_f32_16x16x32_bf16 v[248:251], a[124:127], v[104:107], v[248:251]
    ds_read_b128 a[84:87], v9 offset:16640
    v_exp_f32 v126, v78
    v_mfma_f32_16x16x32_bf16 v[252:255], a[124:127], v[108:111], v[252:255]
    v_add_f32 v7, v7, v124
    s_waitcnt lgkmcnt(5)
    v_mfma_f32_16x16x32_bf16 v[80:83], a[64:67], a[0:3], 0
    ds_read_b128 a[88:91], v10 offset:16640
    v_mfma_f32_16x16x32_bf16 v[88:91], a[64:67], a[32:35], 0
    s_pack_ll_b32_b16 m0, s36, 1
    s_waitcnt lgkmcnt(5)
    v_mfma_f32_16x16x32_bf16 v[80:83], a[68:71], a[4:7], v[80:83]
    ds_read_b128 a[92:95], v11 offset:16640
    v_mfma_f32_16x16x32_bf16 v[88:91], a[68:71], a[36:39], v[88:91]
    buffer_load_dwordx4 v28, s[24:27], s36 offen nt lds
    s_waitcnt lgkmcnt(5)
    v_mfma_f32_16x16x32_bf16 v[80:83], a[72:75], a[8:11], v[80:83]
    ds_read_b128 a[64:67], v8 offset:24576
    v_mfma_f32_16x16x32_bf16 v[88:91], a[72:75], a[40:43], v[88:91]
    v_exp_f32 v127, v79
    s_waitcnt lgkmcnt(5)
    v_mfma_f32_16x16x32_bf16 v[80:83], a[76:79], a[12:15], v[80:83]
    ds_read_b128 a[68:71], v9 offset:24576
    buffer_load_dwordx4 v29, s[24:27], s36 offen offset:1024 nt lds
    v_mfma_f32_16x16x32_bf16 v[88:91], a[76:79], a[44:47], v[88:91]
    s_waitcnt lgkmcnt(5)
    v_mfma_f32_16x16x32_bf16 v[80:83], a[80:83], a[16:19], v[80:83]
    ds_read_b128 a[72:75], v10 offset:24576
    v_mfma_f32_16x16x32_bf16 v[88:91], a[80:83], a[48:51], v[88:91]
    v_add_f32 v7, v7, v125
    v_cvt_pk_bf16_f32 v102, v124, v125
    s_waitcnt lgkmcnt(5)
    v_mfma_f32_16x16x32_bf16 v[80:83], a[84:87], a[20:23], v[80:83]
    ds_read_b128 a[76:79], v11 offset:24576
    v_add_f32 v7, v7, v126
    v_mfma_f32_16x16x32_bf16 v[88:91], a[84:87], a[52:55], v[88:91]
    buffer_load_dwordx4 v30, s[24:27], s36 offen offset:2048 nt lds
    v_add_f32 v7, v7, v127
    s_waitcnt lgkmcnt(5)
    v_mfma_f32_16x16x32_bf16 v[80:83], a[88:91], a[24:27], v[80:83]
    ds_read_b128 a[80:83], v8 offset:24832
    v_cvt_pk_bf16_f32 v103, v126, v127
    v_mfma_f32_16x16x32_bf16 v[88:91], a[88:91], a[56:59], v[88:91]
    buffer_load_dwordx4 v31, s[24:27], s36 offen offset:3072 nt lds
    v_add_f32 v12, v6, v7
    s_waitcnt lgkmcnt(5)
    v_mfma_f32_16x16x32_bf16 v[80:83], a[92:95], a[28:31], v[80:83]
    ds_read_b128 a[84:87], v9 offset:24832
    v_cmp_nge_f32 vcc, s39, v12
    v_mfma_f32_16x16x32_bf16 v[88:91], a[92:95], a[60:63], v[88:91]
    s_cbranch_vccnz L_rare1
L_back1:
    s_waitcnt lgkmcnt(5)
    v_mfma_f32_16x16x32_bf16 v[84:87], a[64:67], a[0:3], 0
    ds_read_b128 a[88:91], v10 offset:24832
    v_add_f32 v4, v4, v6
    v_mfma_f32_16x16x32_bf16 v[92:95], a[64:67], a[32:35], 0
    s_add_u32 s36, s36, 0x4000
    v_add_f32 v5, v5, v7
    s_waitcnt lgkmcnt(5)
    v_mfma_f32_16x16x32_bf16 v[84:87], a[68:71], a[4:7], v[84:87]
    ds_read_b128 a[92:95], v11 offset:24832
    v_add_f32 v80, v80, v2
    v_mfma_f32_16x16x32_bf16 v[92:95], a[68:71], a[36:39], v[92:95]
    v_add_f32 v81, v81, v2
    v_exp_f32 v112, v80
    s_waitcnt lgkmcnt(5)
    v_mfma_f32_16x16x32_bf16 v[84:87], a[72:75], a[8:11], v[84:87]
    s_waitcnt vmcnt(8)
    s_barrier
    ds_read_b64_tr_b16 a[96:97], v16 offset:16384
    v_mfma_f32_16x16x32_bf16 v[92:95], a[72:75], a[40:43], v[92:95]
    ds_read_b64_tr_b16 a[98:99], v16 offset:24576
    buffer_load_dword a132, v40, s[28:31], s51 offen
    v_add_f32 v82, v82, v2
    s_waitcnt lgkmcnt(6)
    v_mfma_f32_16x16x32_bf16 v[84:87], a[76:79], a[12:15], v[84:87]
    ds_read_b64_tr_b16 a[100:101], v17 offset:16384
    v_add_u32 v40, 1536, v40
    v_exp_f32 v113, v81
    v_mfma_f32_16x16x32_bf16 v[92:95], a[76:79], a[44:47], v[92:95]
    ds_read_b64_tr_b16 a[102:103], v17 offset:24576
    v_add_f32 v83, v83, v2
    s_waitcnt lgkmcnt(7)
    v_mfma_f32_16x16x32_bf16 v[84:87], a[80:83], a[16:19], v[84:87]
    ds_read_b64_tr_b16 a[104:105], v18 offset:16384
    v_exp_f32 v114, v82
    v_mfma_f32_16x16x32_bf16 v[92:95], a[80:83], a[48:51], v[92:95]
    ds_read_b64_tr_b16 a[106:107], v18 offset:24576
    v_add_f32 v88, v88, v3
    s_waitcnt lgkmcnt(8)
    v_mfma_f32_16x16x32_bf16 v[84:87], a[84:87], a[20:23], v[84:87]
    ds_read_b64_tr_b16 a[108:109], v19 offset:16384
    v_exp_f32 v115, v83
    v_mfma_f32_16x16x32_bf16 v[92:95], a[84:87], a[52:55], v[92:95]
    ds_read_b64_tr_b16 a[110:111], v19 offset:24576
    v_add_f32 v6, v112, v113
    s_waitcnt lgkmcnt(9)
    v_mfma_f32_16x16x32_bf16 v[84:87], a[88:91], a[24:27], v[84:87]
    ds_read_b64_tr_b16 a[112:113], v20 offset:16384
    v_cvt_pk_bf16_f32 v104, v112, v113
    v_add_f32 v89, v89, v3
    v_mfma_f32_16x16x32_bf16 v[92:95], a[88:91], a[56:59], v[92:95]
    ds_read_b64_tr_b16 a[114:115], v20 offset:24576
    v_exp_f32 v120, v88
    s_waitcnt lgkmcnt(10)
    v_mfma_f32_16x16x32_bf16 v[84:87], a[92:95], a[28:31], v[84:87]
    ds_read_b64_tr_b16 a[116:117], v21 offset:16384
    v_add_f32 v6, v6, v114
    v_exp_f32 v121, v89
    v_mfma_f32_16x16x32_bf16 v[92:95], a[92:95], a[60:63], v[92:95]
    ds_read_b64_tr_b16 a[118:119], v21 offset:24576
    v_add_f32 v6, v6, v115
    v_cvt_pk_bf16_f32 v105, v114, v115
    s_waitcnt lgkmcnt(10)
    v_mfma_f32_16x16x32_bf16 v[128:131], a[96:99], v[96:99], v[128:131]
    ds_read_b64_tr_b16 a[120:121], v22 offset:16384
    s_pack_ll_b32_b16 m0, s35, 0
    v_mfma_f32_16x16x32_bf16 v[132:135], a[96:99], v[100:103], v[132:135]
    ds_read_b64_tr_b16 a[122:123], v22 offset:24576
    v_xor_b32 v8, 0x8000, v8
    s_waitcnt lgkmcnt(10)
    v_mfma_f32_16x16x32_bf16 v[136:139], a[100:103], v[96:99], v[136:139]
    ds_read_b64_tr_b16 a[124:125], v23 offset:16384
    v_add_f32 v90, v90, v3
    v_mfma_f32_16x16x32_bf16 v[140:143], a[100:103], v[100:103], v[140:143]
    ds_read_b64_tr_b16 a[126:127], v23 offset:24576
    buffer_load_dwordx4 v24, s[20:23], s35 offen nt lds
    s_waitcnt lgkmcnt(10)
    v_mfma_f32_16x16x32_bf16 v[144:147], a[104:107], v[96:99], v[144:147]
    ds_read_b64_tr_b16 a[96:97], v16 offset:16640
    v_add_f32 v91, v91, v3
    v_mfma_f32_16x16x32_bf16 v[148:151], a[104:107], v[100:103], v[148:151]
    ds_read_b64_tr_b16 a[98:99], v16 offset:24832
    v_xor_b32 v9, 0x8000, v9
    s_waitcnt lgkmcnt(10)
    v_mfma_f32_16x16x32_bf16 v[152:155], a[108:111], v[96:99], v[152:155]
    ds_read_b64_tr_b16 a[100:101], v17 offset:16640
    buffer_load_dwordx4 v25, s[20:23], s35 offen offset:1024 nt lds
    v_mfma_f32_16x16x32_bf16 v[156:159], a[108:111], v[100:103], v[156:159]
    ds_read_b64_tr_b16 a[102:103], v17 offset:24832
    s_waitcnt lgkmcnt(10)
    v_mfma_f32_16x16x32_bf16 v[160:163], a[112:115], v[96:99], v[160:163]
    ds_read_b64_tr_b16 a[104:105], v18 offset:16640
    v_exp_f32 v122, v90
    v_mfma_f32_16x16x32_bf16 v[164:167], a[112:115], v[100:103], v[164:167]
    ds_read_b64_tr_b16 a[106:107], v18 offset:24832
    v_add_f32 v84, v84, v2
    s_waitcnt lgkmcnt(10)
    v_mfma_f32_16x16x32_bf16 v[168:171], a[116:119], v[96:99], v[168:171]
    ds_read_b64_tr_b16 a[108:109], v19 offset:16640
    buffer_load_dwordx4 v26, s[20:23], s35 offen offset:2048 nt lds
    v_mfma_f32_16x16x32_bf16 v[172:175], a[116:119], v[100:103], v[172:175]
    ds_read_b64_tr_b16 a[110:111], v19 offset:24832
    v_xor_b32 v10, 0x8000, v10
    s_waitcnt lgkmcnt(10)
    v_mfma_f32_16x16x32_bf16 v[176:179], a[120:123], v[96:99], v[176:179]
    ds_read_b64_tr_b16 a[112:113], v20 offset:16640
    v_exp_f32 v123, v91
    v_mfma_f32_16x16x32_bf16 v[180:183], a[120:123], v[100:103], v[180:183]
    ds_read_b64_tr_b16 a[114:115], v20 offset:24832
    buffer_load_dwordx4 v27, s[20:23], s35 offen offset:3072 nt lds
    s_waitcnt lgkmcnt(10)
    v_mfma_f32_16x16x32_bf16 v[184:187], a[124:127], v[96:99], v[184:187]
    ds_read_b64_tr_b16 a[116:117], v21 offset:16640
    v_add_f32 v7, v120, v121
    v_cvt_pk_bf16_f32 v108, v120, v121
    v_mfma_f32_16x16x32_bf16 v[188:191], a[124:127], v[100:103], v[188:191]
    ds_read_b64_tr_b16 a[118:119], v21 offset:24832
    v_xor_b32 v11, 0x8000, v11
    s_waitcnt lgkmcnt(10)
    v_mfma_f32_16x16x32_bf16 v[192:195], a[96:99], v[96:99], v[192:195]
    ds_read_b64_tr_b16 a[120:121], v22 offset:16640
    s_add_u32 s35, s35, 0x4000
    v_add_f32 v85, v85, v2
    v_mfma_f32_16x16x32_bf16 v[196:199], a[96:99], v[100:103], v[196:199]
    ds_read_b64_tr_b16 a[122:123], v22 offset:24832
    v_exp_f32 v116, v84
    s_waitcnt lgkmcnt(10)
    v_mfma_f32_16x16x32_bf16 v[200:203], a[100:103], v[96:99], v[200:203]
    ds_read_b64_tr_b16 a[124:125], v23 offset:16640
    v_add_f32 v7, v7, v122
    v_add_f32 v86, v86, v2
    v_mfma_f32_16x16x32_bf16 v[204:207], a[100:103], v[100:103], v[204:207]
    ds_read_b64_tr_b16 a[126:127], v23 offset:24832
    v_exp_f32 v117, v85
    s_waitcnt lgkmcnt(10)
    v_mfma_f32_16x16x32_bf16 v[208:211], a[104:107], v[96:99], v[208:211]
    s_waitcnt vmcnt(9)
    s_barrier
    ds_read_b128 a[64:67], v8 offset:0
    v_mfma_f32_16x16x32_bf16 v[212:215], a[104:107], v[100:103], v[212:215]
    v_add_f32 v7, v7, v123
    v_cvt_pk_bf16_f32 v109, v122, v123
    v_add_f32 v87, v87, v2
    s_waitcnt lgkmcnt(9)
    v_mfma_f32_16x16x32_bf16 v[216:219], a[108:111], v[96:99], v[216:219]
    ds_read_b128 a[68:71], v9 offset:0
    v_exp_f32 v118, v86
    v_mfma_f32_16x16x32_bf16 v[220:223], a[108:111], v[100:103], v[220:223]
    v_add_f32 v6, v6, v116
    v_add_f32 v92, v92, v3
    s_waitcnt lgkmcnt(8)
    v_mfma_f32_16x16x32_bf16 v[224:227], a[112:115], v[96:99], v[224:227]
    ds_read_b128 a[72:75], v10 offset:0
    v_exp_f32 v119, v87
    v_mfma_f32_16x16x32_bf16 v[228:231], a[112:115], v[100:103], v[228:231]
    v_add_f32 v6, v6, v117
    v_cvt_pk_bf16_f32 v106, v116, v117
    v_add_f32 v93, v93, v3
    s_waitcnt lgkmcnt(7)
    v_mfma_f32_16x16x32_bf16 v[232:235], a[116:119], v[96:99], v[232:235]
    ds_read_b128 a[76:79], v11 offset:0
    v_exp_f32 v124, v92
    v_mfma_f32_16x16x32_bf16 v[236:239], a[116:119], v[100:103], v[236:239]
    v_add_f32 v6, v6, v118
    v_add_f32 v94, v94, v3
    s_waitcnt lgkmcnt(6)
    v_mfma_f32_16x16x32_bf16 v[240:243], a[120:123], v[96:99], v[240:243]
    ds_read_b128 a[80:83], v8 offset:256
    v_exp_f32 v125, v93
    v_mfma_f32_16x16x32_bf16 v[244:247], a[120:123], v[100:103], v[244:247]
    v_add_f32 v6, v6, v119
    v_cvt_pk_bf16_f32 v107, v118, v119
    v_add_f32 v95, v95, v3
    s_waitcnt lgkmcnt(5)
    v_mfma_f32_16x16x32_bf16 v[248:251], a[124:127], v[96:99], v[248:251]
    ds_read_b128 a[84:87], v9 offset:256
    v_exp_f32 v126, v94
    s_sub_u32 s37, s37, 1
    v_mfma_f32_16x16x32_bf16 v[252:255], a[124:127], v[100:103], v[252:255]
    s_cmp_lg_u32 s37, 6
    v_add_f32 v7, v7, v124
    s_cbranch_scc1 L_loopA
    s_pack_ll_b32_b16 m0, s36, 1
    s_nop 0
    buffer_load_dwordx4 v28, s[24:27], s36 offen nt lds
    buffer_load_dwordx4 v29, s[24:27], s36 offen offset:1024 nt lds
    buffer_load_dwordx4 v30, s[24:27], s36 offen offset:2048 nt lds
    buffer_load_dwordx4 v31, s[24:27], s36 offen offset:3072 nt lds
    s_add_u32 s36, s36, 0x4000
    s_waitcnt vmcnt(9)
    s_barrier
L_loop:
    s_waitcnt lgkmcnt(2)
    v_mfma_f32_16x16x32_bf16 v[64:67], a[64:67], a[0:3], v[48:51]
    ds_read_b128 a[88:91], v10 offset:256
    v_xor_b32 v16, 0x8000, v16
    v_mfma_f32_16x16x32_bf16 v[72:75], a[64:67], a[32:35], v[52:55]
    s_pack_ll_b32_b16 m0, s35, 0
    v_exp_f32 v127, v95
    v_mfma_f32_16x16x32_bf16 v[64:67], a[68:71], a[4:7], v[64:67]
    ds_read_b128 a[92:95], v11 offset:256
    v_xor_b32 v17, 0x8000, v17
    v_mfma_f32_16x16x32_bf16 v[72:75], a[68:71], a[36:39], v[72:75]
    buffer_load_dwordx4 v24, s[20:23], s35 offen nt lds
    v_add_f32 v7, v7, v125
    v_mfma_f32_16x16x32_bf16 v[64:67], a[72:75], a[8:11], v[64:67]
    ds_read_b128 a[64:67], v8 offset:8192
    v_cvt_pk_bf16_f32 v110, v124, v125
    v_mfma_f32_16x16x32_bf16 v[72:75], a[72:75], a[40:43], v[72:75]
    v_xor_b32 v18, 0x8000, v18
    v_add_f32 v7, v7, v126
    v_mfma_f32_16x16x32_bf16 v[64:67], a[76:79], a[12:15], v[64:67]
    ds_read_b128 a[68:71], v9 offset:8192
    buffer_load_dwordx4 v25, s[20:23], s35 offen offset:1024 nt lds
    v_mfma_f32_16x16x32_bf16 v[72:75], a[76:79], a[44:47], v[72:75]
    v_xor_b32 v19, 0x8000, v19
    s_waitcnt lgkmcnt(2)
    v_mfma_f32_16x16x32_bf16 v[64:67], a[80:83], a[16:19], v[64:67]
    ds_read_b128 a[72:75], v10 offset:8192
    v_add_f32 v7, v7, v127
    v_mfma_f32_16x16x32_bf16 v[72:75], a[80:83], a[48:51], v[72:75]
    v_cvt_pk_bf16_f32 v111, v126, v127
    v_add_f32 v12, v6, v7
    v_mfma_f32_16x16x32_bf16 v[64:67], a[84:87], a[20:23], v[64:67]
    ds_read_b128 a[76:79], v11 offset:8192
    v_xor_b32 v20, 0x8000, v20
    v_mfma_f32_16x16x32_bf16 v[72:75], a[84:87], a[52:55], v[72:75]
    buffer_load_dwordx4 v26, s[20:23], s35 offen offset:2048 nt lds
    v_cmp_nge_f32 vcc, s39, v12
    v_mfma_f32_16x16x32_bf16 v[64:67], a[88:91], a[24:27], v[64:67]
    ds_read_b128 a[80:83], v8 offset:8448
    v_xor_b32 v21, 0x8000, v21
    v_mfma_f32_16x16x32_bf16 v[72:75], a[88:91], a[56:59], v[72:75]
    buffer_load_dwordx4 v27, s[20:23], s35 offen offset:3072 nt lds
    s_cbranch_vccnz L_rare2
L_back2:
    v_mfma_f32_16x16x32_bf16 v[64:67], a[92:95], a[28:31], v[64:67]
    ds_read_b128 a[84:87], v9 offset:8448
    v_add_f32 v4, v4, v6
    v_mfma_f32_16x16x32_bf16 v[72:75], a[92:95], a[60:63], v[72:75]
    v_xor_b32 v22, 0x8000, v22
    s_waitcnt lgkmcnt(2)
    v_mfma_f32_16x16x32_bf16 v[68:71], a[64:67], a[0:3], v[48:51]
    ds_read_b128 a[88:91], v10 offset:8448
    v_add_f32 v5, v5, v7
    v_mfma_f32_16x16x32_bf16 v[76:79], a[64:67], a[32:35], v[52:55]
    s_add_u32 s35, s35, 0x4000
    v_xor_b32 v23, 0x8000, v23
    v_mfma_f32_16x16x32_bf16 v[68:71], a[68:71], a[4:7], v[68:71]
    ds_read_b128 a[92:95], v11 offset:8448
    v_exp_f32 v112, v64
    v_mfma_f32_16x16x32_bf16 v[76:79], a[68:71], a[36:39], v[76:79]
    v_exp_f32 v113, v65
    v_mfma_f32_16x16x32_bf16 v[68:71], a[72:75], a[8:11], v[68:71]
    ds_read_b64_tr_b16 a[96:97], v16 offset:0
    v_exp_f32 v114, v66
    v_mfma_f32_16x16x32_bf16 v[76:79], a[72:75], a[40:43], v[76:79]
    ds_read_b64_tr_b16 a[98:99], v16 offset:8192
    v_exp_f32 v115, v67
    v_mfma_f32_16x16x32_bf16 v[68:71], a[76:79], a[12:15], v[68:71]
    ds_read_b64_tr_b16 a[100:101], v17 offset:0
    v_add_f32 v6, v112, v113
    v_mfma_f32_16x16x32_bf16 v[76:79], a[76:79], a[44:47], v[76:79]
    ds_read_b64_tr_b16 a[102:103], v17 offset:8192
    s_waitcnt lgkmcnt(4)
    v_mfma_f32_16x16x32_bf16 v[68:71], a[80:83], a[16:19], v[68:71]
    ds_read_b64_tr_b16 a[104:105], v18 offset:0
    v_cvt_pk_bf16_f32 v96, v112, v113
    v_mfma_f32_16x16x32_bf16 v[76:79], a[80:83], a[48:51], v[76:79]
    ds_read_b64_tr_b16 a[106:107], v18 offset:8192
    v_exp_f32 v120, v72
    v_mfma_f32_16x16x32_bf16 v[68:71], a[84:87], a[20:23], v[68:71]
    ds_read_b64_tr_b16 a[108:109], v19 offset:0
    v_mfma_f32_16x16x32_bf16 v[76:79], a[84:87], a[52:55], v[76:79]
    ds_read_b64_tr_b16 a[110:111], v19 offset:8192
    v_add_f32 v6, v6, v114
    v_mfma_f32_16x16x32_bf16 v[68:71], a[88:91], a[24:27], v[68:71]
    ds_read_b64_tr_b16 a[112:113], v20 offset:0
    v_exp_f32 v121, v73
    v_mfma_f32_16x16x32_bf16 v[76:79], a[88:91], a[56:59], v[76:79]
    ds_read_b64_tr_b16 a[114:115], v20 offset:8192
    v_add_f32 v6, v6, v115
    v_mfma_f32_16x16x32_bf16 v[68:71], a[92:95], a[28:31], v[68:71]
    ds_read_b64_tr_b16 a[116:117], v21 offset:0
    v_cvt_pk_bf16_f32 v97, v114, v115
    v_mfma_f32_16x16x32_bf16 v[76:79], a[92:95], a[60:63], v[76:79]
    ds_read_b64_tr_b16 a[118:119], v21 offset:8192
    s_waitcnt lgkmcnt(4)
    v_mfma_f32_16x16x32_bf16 v[128:131], a[96:99], v[104:107], v[128:131]
    ds_read_b64_tr_b16 a[120:121], v22 offset:0
    s_pack_ll_b32_b16 m0, s36, 1
    v_mfma_f32_16x16x32_bf16 v[132:135], a[96:99], v[108:111], v[132:135]
    ds_read_b64_tr_b16 a[122:123], v22 offset:8192
    v_mfma_f32_16x16x32_bf16 v[136:139], a[100:103], v[104:107], v[136:139]
    ds_read_b64_tr_b16 a[124:125], v23 offset:0
    v_exp_f32 v122, v74
    v_mfma_f32_16x16x32_bf16 v[140:143], a[100:103], v[108:111], v[140:143]
    ds_read_b64_tr_b16 a[126:127], v23 offset:8192
    buffer_load_dwordx4 v28, s[24:27], s36 offen nt lds
    v_mfma_f32_16x16x32_bf16 v[144:147], a[104:107], v[104:107], v[144:147]
    ds_read_b64_tr_b16 a[96:97], v16 offset:256
    v_exp_f32 v123, v75
    v_mfma_f32_16x16x32_bf16 v[148:151], a[104:107], v[108:111], v[148:151]
    ds_read_b64_tr_b16 a[98:99], v16 offset:8448
    v_mfma_f32_16x16x32_bf16 v[152:155], a[108:111], v[104:107], v[152:155]
    ds_read_b64_tr_b16 a[100:101], v17 offset:256
    buffer_load_dwordx4 v29, s[24:27], s36 offen offset:1024 nt lds
    v_mfma_f32_16x16x32_bf16 v[156:159], a[108:111], v[108:111], v[156:159]
    ds_read_b64_tr_b16 a[102:103], v17 offset:8448
    s_waitcnt lgkmcnt(4)
    v_mfma_f32_16x16x32_bf16 v[160:163], a[112:115], v[104:107], v[160:163]
    ds_read_b64_tr_b16 a[104:105], v18 offset:256
    v_add_f32 v7, v120, v121
    v_mfma_f32_16x16x32_bf16 v[164:167], a[112:115], v[108:111], v[164:167]
    ds_read_b64_tr_b16 a[106:107], v18 offset:8448
    v_cvt_pk_bf16_f32 v100, v120, v121
    v_mfma_f32_16x16x32_bf16 v[168:171], a[116:119], v[104:107], v[168:171]
    ds_read_b64_tr_b16 a[108:109], v19 offset:256
    buffer_load_dwordx4 v30, s[24:27], s36 offen offset:2048 nt lds
    v_mfma_f32_16x16x32_bf16 v[172:175], a[116:119], v[108:111], v[172:175]
    ds_read_b64_tr_b16 a[110:111], v19 offset:8448
    v_mfma_f32_16x16x32_bf16 v[176:179], a[120:123], v[104:107], v[176:179]
    ds_read_b64_tr_b16 a[112:113], v20 offset:256
    v_exp_f32 v116, v68
    v_mfma_f32_16x16x32_bf16 v[180:183], a[120:123], v[108:111], v[180:183]
    ds_read_b64_tr_b16 a[114:115], v20 offset:8448
    buffer_load_dwordx4 v31, s[24:27], s36 offen offset:3072 nt lds
    v_mfma_f32_16x16x32_bf16 v[184:187], a[124:127], v[104:107], v[184:187]
    ds_read_b64_tr_b16 a[116:117], v21 offset:256
    v_add_f32 v7, v7, v122
    v_mfma_f32_16x16x32_bf16 v[188:191], a[124:127], v[108:111], v[188:191]
    ds_read_b64_tr_b16 a[118:119], v21 offset:8448
    s_waitcnt lgkmcnt(4)
    v_mfma_f32_16x16x32_bf16 v[192:195], a[96:99], v[104:107], v[192:195]
    ds_read_b64_tr_b16 a[120:121], v22 offset:256
    s_add_u32 s36, s36, 0x4000
    v_mfma_f32_16x16x32_bf16 v[196:199], a[96:99], v[108:111], v[196:199]
    ds_read_b64_tr_b16 a[122:123], v22 offset:8448
    v_exp_f32 v117, v69
    v_mfma_f32_16x16x32_bf16 v[200:203], a[100:103], v[104:107], v[200:203]
    ds_read_b64_tr_b16 a[124:125], v23 offset:256
    v_add_f32 v7, v7, v123
    v_mfma_f32_16x16x32_bf16 v[204:207], a[100:103], v[108:111], v[204:207]
    ds_read_b64_tr_b16 a[126:127], v23 offset:8448
    v_cvt_pk_bf16_f32 v101, v122, v123
    v_mfma_f32_16x16x32_bf16 v[208:211], a[104:107], v[104:107], v[208:211]
    s_waitcnt vmcnt(8)
    s_barrier
    ds_read_b128 a[64:67], v8 offset:16384
    v_mfma_f32_16x16x32_bf16 v[212:215], a[104:107], v[108:111], v[212:215]
    v_exp_f32 v118, v70
    v_mfma_f32_16x16x32_bf16 v[216:219], a[108:111], v[104:107], v[216:219]
    ds_read_b128 a[68:71], v9 offset:16384
    v_add_f32 v6, v6, v116
    v_mfma_f32_16x16x32_bf16 v[220:223], a[108:111], v[108:111], v[220:223]
    v_exp_f32 v119, v71
    s_waitcnt lgkmcnt(2)
    v_mfma_f32_16x16x32_bf16 v[224:227], a[112:115], v[104:107], v[224:227]
    ds_read_b128 a[72:75], v10 offset:16384
    v_add_f32 v6, v6, v117
    v_mfma_f32_16x16x32_bf16 v[228:231], a[112:115], v[108:111], v[228:231]
    v_cvt_pk_bf16_f32 v98, v116, v117
    v_exp_f32 v124, v76
    v_mfma_f32_16x16x32_bf16 v[232:235], a[116:119], v[104:107], v[232:235]
    ds_read_b128 a[76:79], v11 offset:16384
    v_add_f32 v6, v6, v118
    v_mfma_f32_16x16x32_bf16 v[236:239], a[116:119], v[108:111], v[236:239]
    v_exp_f32 v125, v77
    v_mfma_f32_16x16x32_bf16 v[240:243], a[120:123], v[104:107], v[240:243]
    ds_read_b128 a[80:83], v8 offset:16640
    v_mfma_f32_16x16x32_bf16 v[244:247], a[120:123], v[108:111], v[244:247]
    v_add_f32 v6, v6, v119
    v_cvt_pk_bf16_f32 v99, v118, v119
    v_mfma_f32_16x16x32_bf16 v[248:251], a[124:127], v[104:107], v[248:251]
    ds_read_b128 a[84:87], v9 offset:16640
    v_exp_f32 v126, v78
    v_mfma_f32_16x16x32_bf16 v[252:255], a[124:127], v[108:111], v[252:255]
    v_add_f32 v7, v7, v124
    s_waitcnt lgkmcnt(2)
    v_mfma_f32_16x16x32_bf16 v[80:83], a[64:67], a[0:3], v[48:51]
    ds_read_b128 a[88:91], v10 offset:16640
    v_mfma_f32_16x16x32_bf16 v[88:91], a[64:67], a[32:35], v[52:55]
    s_pack_ll_b32_b16 m0, s35, 0
    v_exp_f32 v127, v79
    v_mfma_f32_16x16x32_bf16 v[80:83], a[68:71], a[4:7], v[80:83]
    ds_read_b128 a[92:95], v11 offset:16640
    v_mfma_f32_16x16x32_bf16 v[88:91], a[68:71], a[36:39], v[88:91]
    buffer_load_dwordx4 v24, s[20:23], s35 offen nt lds
    v_add_f32 v7, v7, v125
    v_mfma_f32_16x16x32_bf16 v[80:83], a[72:75], a[8:11], v[80:83]
    ds_read_b128 a[64:67], v8 offset:24576
    v_cvt_pk_bf16_f32 v102, v124, v125
    v_mfma_f32_16x16x32_bf16 v[88:91], a[72:75], a[40:43], v[88:91]
    v_add_f32 v7, v7, v126
    v_mfma_f32_16x16x32_bf16 v[80:83], a[76:79], a[12:15], v[80:83]
    ds_read_b128 a[68:71], v9 offset:24576
    buffer_load_dwordx4 v25, s[20:23], s35 offen offset:1024 nt lds
    v_mfma_f32_16x16x32_bf16 v[88:91], a[76:79], a[44:47], v[88:91]
    s_waitcnt lgkmcnt(2)
    v_mfma_f32_16x16x32_bf16 v[80:83], a[80:83], a[16:19], v[80:83]
    ds_read_b128 a[72:75], v10 offset:24576
    v_add_f32 v7, v7, v127
    v_mfma_f32_16x16x32_bf16 v[88:91], a[80:83], a[48:51], v[88:91]
    v_cvt_pk_bf16_f32 v103, v126, v127
    v_add_f32 v12, v6, v7
    v_mfma_f32_16x16x32_bf16 v[80:83], a[84:87], a[20:23], v[80:83]
    ds_read_b128 a[76:79], v11 offset:24576
    v_mfma_f32_16x16x32_bf16 v[88:91], a[84:87], a[52:55], v[88:91]
    buffer_load_dwordx4 v26, s[20:23], s35 offen offset:2048 nt lds
    v_cmp_nge_f32 vcc, s39, v12
    v_mfma_f32_16x16x32_bf16 v[80:83], a[88:91], a[24:27], v[80:83]
    ds_read_b128 a[80:83], v8 offset:24832
    v_mfma_f32_16x16x32_bf16 v[88:91], a[88:91], a[56:59], v[88:91]
    buffer_load_dwordx4 v27, s[20:23], s35 offen offset:3072 nt lds
    s_cbranch_vccnz L_rare3
L_back3:
    v_mfma_f32_16x16x32_bf16 v[80:83], a[92:95], a[28:31], v[80:83]
    ds_read_b128 a[84:87], v9 offset:24832
    v_add_f32 v4, v4, v6
    v_mfma_f32_16x16x32_bf16 v[88:91], a[92:95], a[60:63], v[88:91]
    s_waitcnt lgkmcnt(2)
    v_mfma_f32_16x16x32_bf16 v[84:87], a[64:67], a[0:3], v[48:51]
    ds_read_b128 a[88:91], v10 offset:24832
    v_add_f32 v5, v5, v7
    v_mfma_f32_16x16x32_bf16 v[92:95], a[64:67], a[32:35], v[52:55]
    s_add_u32 s35, s35, 0x4000
    v_mfma_f32_16x16x32_bf16 v[84:87], a[68:71], a[4:7], v[84:87]
    ds_read_b128 a[92:95], v11 offset:24832
    v_exp_f32 v112, v80
    v_mfma_f32_16x16x32_bf16 v[92:95], a[68:71], a[36:39], v[92:95]
    v_exp_f32 v113, v81
    v_mfma_f32_16x16x32_bf16 v[84:87], a[72:75], a[8:11], v[84:87]
    ds_read_b64_tr_b16 a[96:97], v16 offset:16384
    v_exp_f32 v114, v82
    v_mfma_f32_16x16x32_bf16 v[92:95], a[72:75], a[40:43], v[92:95]
    ds_read_b64_tr_b16 a[98:99], v16 offset:24576
    v_exp_f32 v115, v83
    buffer_load_dword a132, v40, s[28:31], s51 offen
    v_mfma_f32_16x16x32_bf16 v[84:87], a[76:79], a[12:15], v[84:87]
    ds_read_b64_tr_b16 a[100:101], v17 offset:16384
    v_add_f32 v6, v112, v113
    v_add_u32 v40, 1536, v40
    v_mfma_f32_16x16x32_bf16 v[92:95], a[76:79], a[44:47], v[92:95]
    ds_read_b64_tr_b16 a[102:103], v17 offset:24576
    s_waitcnt lgkmcnt(4)
    v_mfma_f32_16x16x32_bf16 v[84:87], a[80:83], a[16:19], v[84:87]
    ds_read_b64_tr_b16 a[104:105], v18 offset:16384
    v_cvt_pk_bf16_f32 v104, v112, v113
    v_mfma_f32_16x16x32_bf16 v[92:95], a[80:83], a[48:51], v[92:95]
    ds_read_b64_tr_b16 a[106:107], v18 offset:24576
    v_exp_f32 v120, v88
    v_mfma_f32_16x16x32_bf16 v[84:87], a[84:87], a[20:23], v[84:87]
    ds_read_b64_tr_b16 a[108:109], v19 offset:16384
    v_mfma_f32_16x16x32_bf16 v[92:95], a[84:87], a[52:55], v[92:95]
    ds_read_b64_tr_b16 a[110:111], v19 offset:24576
    v_add_f32 v6, v6, v114
    v_mfma_f32_16x16x32_bf16 v[84:87], a[88:91], a[24:27], v[84:87]
    ds_read_b64_tr_b16 a[112:113], v20 offset:16384
    v_exp_f32 v121, v89
    v_mfma_f32_16x16x32_bf16 v[92:95], a[88:91], a[56:59], v[92:95]
    ds_read_b64_tr_b16 a[114:115], v20 offset:24576
    v_add_f32 v6, v6, v115
    v_mfma_f32_16x16x32_bf16 v[84:87], a[92:95], a[28:31], v[84:87]
    ds_read_b64_tr_b16 a[116:117], v21 offset:16384
    v_cvt_pk_bf16_f32 v105, v114, v115
    s_sub_u32 s37, s37, 1
    v_mfma_f32_16x16x32_bf16 v[92:95], a[92:95], a[60:63], v[92:95]
    s_cmp_eq_u32 s37, 0
    ds_read_b64_tr_b16 a[118:119], v21 offset:24576
    s_cbranch_scc1 L_tail
    s_waitcnt lgkmcnt(4)
    v_mfma_f32_16x16x32_bf16 v[128:131], a[96:99], v[96:99], v[128:131]
    ds_read_b64_tr_b16 a[120:121], v22 offset:16384
    s_pack_ll_b32_b16 m0, s36, 1
    v_mfma_f32_16x16x32_bf16 v[132:135], a[96:99], v[100:103], v[132:135]
    ds_read_b64_tr_b16 a[122:123], v22 offset:24576
    v_xor_b32 v8, 0x8000, v8
    v_mfma_f32_16x16x32_bf16 v[136:139], a[100:103], v[96:99], v[136:139]
    ds_read_b64_tr_b16 a[124:125], v23 offset:16384
    v_exp_f32 v122, v90
    v_mfma_f32_16x16x32_bf16 v[140:143], a[100:103], v[100:103], v[140:143]
    ds_read_b64_tr_b16 a[126:127], v23 offset:24576
    buffer_load_dwordx4 v28, s[24:27], s36 offen nt lds
    v_mfma_f32_16x16x32_bf16 v[144:147], a[104:107], v[96:99], v[144:147]
    ds_read_b64_tr_b16 a[96:97], v16 offset:16640
    v_exp_f32 v123, v91
    v_mfma_f32_16x16x32_bf16 v[148:151], a[104:107], v[100:103], v[148:151]
    ds_read_b64_tr_b16 a[98:99], v16 offset:24832
    v_xor_b32 v9, 0x8000, v9
    v_mfma_f32_16x16x32_bf16 v[152:155], a[108:111], v[96:99], v[152:155]
    ds_read_b64_tr_b16 a[100:101], v17 offset:16640
    buffer_load_dwordx4 v29, s[24:27], s36 offen offset:1024 nt lds
    v_mfma_f32_16x16x32_bf16 v[156:159], a[108:111], v[100:103], v[156:159]
    ds_read_b64_tr_b16 a[102:103], v17 offset:24832
    s_waitcnt lgkmcnt(4)
    v_mfma_f32_16x16x32_bf16 v[160:163], a[112:115], v[96:99], v[160:163]
    ds_read_b64_tr_b16 a[104:105], v18 offset:16640
    v_add_f32 v7, v120, v121
    v_mfma_f32_16x16x32_bf16 v[164:167], a[112:115], v[100:103], v[164:167]
    ds_read_b64_tr_b16 a[106:107], v18 offset:24832
    v_cvt_pk_bf16_f32 v108, v120, v121
    v_mfma_f32_16x16x32_bf16 v[168:171], a[116:119], v[96:99], v[168:171]
    ds_read_b64_tr_b16 a[108:109], v19 offset:16640
    buffer_load_dwordx4 v30, s[24:27], s36 offen offset:2048 nt lds
    v_mfma_f32_16x16x32_bf16 v[172:175], a[116:119], v[100:103], v[172:175]
    ds_read_b64_tr_b16 a[110:111], v19 offset:24832
    v_xor_b32 v10, 0x8000, v10
    v_mfma_f32_16x16x32_bf16 v[176:179], a[120:123], v[96:99], v[176:179]
    ds_read_b64_tr_b16 a[112:113], v20 offset:16640
    v_exp_f32 v116, v84
    v_mfma_f32_16x16x32_bf16 v[180:183], a[120:123], v[100:103], v[180:183]
    ds_read_b64_tr_b16 a[114:115], v20 offset:24832
    buffer_load_dwordx4 v31, s[24:27], s36 offen offset:3072 nt lds
    v_mfma_f32_16x16x32_bf16 v[184:187], a[124:127], v[96:99], v[184:187]
    ds_read_b64_tr_b16 a[116:117], v21 offset:16640
    v_add_f32 v7, v7, v122
    v_mfma_f32_16x16x32_bf16 v[188:191], a[124:127], v[100:103], v[188:191]
    ds_read_b64_tr_b16 a[118:119], v21 offset:24832
    v_xor_b32 v11, 0x8000, v11
    s_waitcnt lgkmcnt(4)
    v_mfma_f32_16x16x32_bf16 v[192:195], a[96:99], v[96:99], v[192:195]
    ds_read_b64_tr_b16 a[120:121], v22 offset:16640
    s_add_u32 s36, s36, 0x4000
    v_mfma_f32_16x16x32_bf16 v[196:199], a[96:99], v[100:103], v[196:199]
    ds_read_b64_tr_b16 a[122:123], v22 offset:24832
    v_exp_f32 v117, v85
    v_mfma_f32_16x16x32_bf16 v[200:203], a[100:103], v[96:99], v[200:203]
    ds_read_b64_tr_b16 a[124:125], v23 offset:16640
    v_add_f32 v7, v7, v123
    v_mfma_f32_16x16x32_bf16 v[204:207], a[100:103], v[100:103], v[204:207]
    ds_read_b64_tr_b16 a[126:127], v23 offset:24832
    v_cvt_pk_bf16_f32 v109, v122, v123
    v_mfma_f32_16x16x32_bf16 v[208:211], a[104:107], v[96:99], v[208:211]
    s_waitcnt vmcnt(9)
    s_barrier
    ds_read_b128 a[64:67], v8 offset:0
    v_mfma_f32_16x16x32_bf16 v[212:215], a[104:107], v[100:103], v[212:215]
    v_exp_f32 v118, v86
    v_mfma_f32_16x16x32_bf16 v[216:219], a[108:111], v[96:99], v[216:219]
    ds_read_b128 a[68:71], v9 offset:0
    v_add_f32 v6, v6, v116
    v_mfma_f32_16x16x32_bf16 v[220:223], a[108:111], v[100:103], v[220:223]
    v_exp_f32 v119, v87
    s_waitcnt lgkmcnt(2)
    v_mfma_f32_16x16x32_bf16 v[224:227], a[112:115], v[96:99], v[224:227]
    ds_read_b128 a[72:75], v10 offset:0
    v_add_f32 v6, v6, v117
    v_mfma_f32_16x16x32_bf16 v[228:231], a[112:115], v[100:103], v[228:231]
    v_cvt_pk_bf16_f32 v106, v116, v117
    v_exp_f32 v124, v92
    v_mfma_f32_16x16x32_bf16 v[232:235], a[116:119], v[96:99], v[232:235]
    ds_read_b128 a[76:79], v11 offset:0
    v_add_f32 v6, v6, v118
    v_mfma_f32_16x16x32_bf16 v[236:239], a[116:119], v[100:103], v[236:239]
    v_exp_f32 v125, v93
    v_mfma_f32_16x16x32_bf16 v[240:243], a[120:123], v[96:99], v[240:243]
    ds_read_b128 a[80:83], v8 offset:256
    v_mfma_f32_16x16x32_bf16 v[244:247], a[120:123], v[100:103], v[244:247]
    v_add_f32 v6, v6, v119
    v_cvt_pk_bf16_f32 v107, v118, v119
    v_mfma_f32_16x16x32_bf16 v[248:251], a[124:127], v[96:99], v[248:251]
    ds_read_b128 a[84:87], v9 offset:256
    v_exp_f32 v126, v94
    v_mfma_f32_16x16x32_bf16 v[252:255], a[124:127], v[100:103], v[252:255]
    v_add_f32 v7, v7, v124
    s_branch L_loop
L_tail:
    s_waitcnt lgkmcnt(4)
    v_mfma_f32_16x16x32_bf16 v[128:131], a[96:99], v[96:99], v[128:131]
    ds_read_b64_tr_b16 a[120:121], v22 offset:16384
    buffer_load_dword a132, v35, s[28:31], s51 offen
    v_mfma_f32_16x16x32_bf16 v[132:135], a[96:99], v[100:103], v[132:135]
    ds_read_b64_tr_b16 a[122:123], v22 offset:24576
    v_mov_b32 v8, v41
    v_mfma_f32_16x16x32_bf16 v[136:139], a[100:103], v[96:99], v[136:139]
    ds_read_b64_tr_b16 a[124:125], v23 offset:16384
    v_accvgpr_read_b32 v14, a128
    v_accvgpr_read_b32 v15, a129
    v_mfma_f32_16x16x32_bf16 v[140:143], a[100:103], v[100:103], v[140:143]
    ds_read_b64_tr_b16 a[126:127], v23 offset:24576
    v_exp_f32 v122, v90
    v_exp_f32 v123, v91
    v_mfma_f32_16x16x32_bf16 v[144:147], a[104:107], v[96:99], v[144:147]
    s_waitcnt vmcnt(6)
    s_barrier
    ds_read_b64_tr_b16 a[96:97], v16 offset:32768
    v_add_f32 v7, v120, v121
    v_mfma_f32_16x16x32_bf16 v[148:151], a[104:107], v[100:103], v[148:151]
    ds_read_b64_tr_b16 a[98:99], v16 offset:40960
    v_cvt_pk_bf16_f32 v108, v120, v121
    v_exp_f32 v116, v84
    v_mfma_f32_16x16x32_bf16 v[152:155], a[108:111], v[96:99], v[152:155]
    ds_read_b64_tr_b16 a[100:101], v17 offset:32768
    v_add_f32 v7, v7, v122
    v_exp_f32 v117, v85
    v_add_f32 v7, v7, v123
    v_mfma_f32_16x16x32_bf16 v[156:159], a[108:111], v[100:103], v[156:159]
    ds_read_b64_tr_b16 a[102:103], v17 offset:40960
    v_cvt_pk_bf16_f32 v109, v122, v123
    v_exp_f32 v118, v86
    s_waitcnt lgkmcnt(4)
    v_mfma_f32_16x16x32_bf16 v[160:163], a[112:115], v[96:99], v[160:163]
    ds_read_b64_tr_b16 a[104:105], v18 offset:32768
    v_add_f32 v6, v6, v116
    v_exp_f32 v119, v87
    v_mfma_f32_16x16x32_bf16 v[164:167], a[112:115], v[100:103], v[164:167]
    ds_read_b64_tr_b16 a[106:107], v18 offset:40960
    v_add_f32 v6, v6, v117
    v_cvt_pk_bf16_f32 v106, v116, v117
    v_exp_f32 v124, v92
    v_mfma_f32_16x16x32_bf16 v[168:171], a[116:119], v[96:99], v[168:171]
    ds_read_b64_tr_b16 a[108:109], v19 offset:32768
    v_add_f32 v6, v6, v118
    v_exp_f32 v125, v93
    v_mfma_f32_16x16x32_bf16 v[172:175], a[116:119], v[100:103], v[172:175]
    ds_read_b64_tr_b16 a[110:111], v19 offset:40960
    v_add_f32 v6, v6, v119
    v_cvt_pk_bf16_f32 v107, v118, v119
    v_exp_f32 v126, v94
    v_mfma_f32_16x16x32_bf16 v[176:179], a[120:123], v[96:99], v[176:179]
    ds_read_b64_tr_b16 a[112:113], v20 offset:32768
    v_add_f32 v7, v7, v124
    v_exp_f32 v127, v95
    v_mfma_f32_16x16x32_bf16 v[180:183], a[120:123], v[100:103], v[180:183]
    ds_read_b64_tr_b16 a[114:115], v20 offset:40960
    v_add_f32 v7, v7, v125
    v_cvt_pk_bf16_f32 v110, v124, v125
    v_add_f32 v7, v7, v126
    v_mfma_f32_16x16x32_bf16 v[184:187], a[124:127], v[96:99], v[184:187]
    ds_read_b64_tr_b16 a[116:117], v21 offset:32768
    v_add_f32 v7, v7, v127
    v_cvt_pk_bf16_f32 v111, v126, v127
    v_readfirstlane_b32 s42, v14
    v_readfirstlane_b32 s43, v15
    v_mfma_f32_16x16x32_bf16 v[188:191], a[124:127], v[100:103], v[188:191]
    ds_read_b64_tr_b16 a[118:119], v21 offset:40960
    v_add_f32 v12, v6, v7
    v_cmp_nge_f32 vcc, s39, v12
    s_cbranch_vccnz L_rare4
L_back4:
    s_nop 0
    s_waitcnt lgkmcnt(4)
    v_mfma_f32_16x16x32_bf16 v[128:131], a[96:99], v[104:107], v[128:131]
    ds_read_b64_tr_b16 a[120:121], v22 offset:32768
    v_add_f32 v4, v4, v6
    v_add_f32 v5, v5, v7
    v_mfma_f32_16x16x32_bf16 v[132:135], a[96:99], v[108:111], v[132:135]
    ds_read_b64_tr_b16 a[122:123], v22 offset:40960
    s_and_b32 s44, s42, 15
    s_xor_b32 s44, s44, s49
    v_mfma_f32_16x16x32_bf16 v[136:139], a[100:103], v[104:107], v[136:139]
    ds_read_b64_tr_b16 a[124:125], v23 offset:32768
    s_cmp_lg_u32 s44, 0
    s_cselect_b32 s67, 0x7fff0000, s46
    v_mfma_f32_16x16x32_bf16 v[140:143], a[100:103], v[108:111], v[140:143]
    ds_read_b64_tr_b16 a[126:127], v23 offset:40960
    v_mov_b32 v12, v4
    v_mov_b32 v13, v5
    s_nop 0
    v_permlane16_swap_b32 v4, v12
    v_permlane16_swap_b32 v5, v13
    v_mfma_f32_16x16x32_bf16 v[144:147], a[104:107], v[104:107], v[144:147]
    ds_read_b64_tr_b16 a[96:97], v16 offset:16640
    v_add_f32 v4, v4, v12
    v_add_f32 v5, v5, v13
    v_mfma_f32_16x16x32_bf16 v[148:151], a[104:107], v[108:111], v[148:151]
    ds_read_b64_tr_b16 a[98:99], v16 offset:24832
    v_mov_b32 v12, v4
    v_mov_b32 v13, v5
    s_nop 0
    v_permlane32_swap_b32 v4, v12
    v_permlane32_swap_b32 v5, v13
    v_mfma_f32_16x16x32_bf16 v[152:155], a[108:111], v[104:107], v[152:155]
    ds_read_b64_tr_b16 a[100:101], v17 offset:16640
    v_add_f32 v4, v4, v12
    v_add_f32 v5, v5, v13
    buffer_store_dwordx4 v[2:5], v8, s[12:15], s48 offen
    v_mfma_f32_16x16x32_bf16 v[156:159], a[108:111], v[108:111], v[156:159]
    ds_read_b64_tr_b16 a[102:103], v17 offset:24832
    v_cvt_pk_bf16_f32 v32, v128, v129
    v_cvt_pk_bf16_f32 v33, v130, v131
    s_waitcnt lgkmcnt(4)
    v_mfma_f32_16x16x32_bf16 v[160:163], a[112:115], v[104:107], v[160:163]
    ds_read_b64_tr_b16 a[104:105], v18 offset:16640
    v_cvt_pk_bf16_f32 v34, v132, v133
    v_cvt_pk_bf16_f32 v35, v134, v135
    buffer_store_dwordx4 v[32:35], v1, s[28:31], s57 offen
    v_mfma_f32_16x16x32_bf16 v[164:167], a[112:115], v[108:111], v[164:167]
    ds_read_b64_tr_b16 a[106:107], v18 offset:24832
    v_cvt_pk_bf16_f32 v36, v136, v137
    v_cvt_pk_bf16_f32 v37, v138, v139
    v_mfma_f32_16x16x32_bf16 v[168:171], a[116:119], v[104:107], v[168:171]
    ds_read_b64_tr_b16 a[108:109], v19 offset:16640
    v_cvt_pk_bf16_f32 v38, v140, v141
    v_cvt_pk_bf16_f32 v39, v142, v143
    buffer_store_dwordx4 v[36:39], v1, s[28:31], s57 offen offset:2048
    v_mfma_f32_16x16x32_bf16 v[172:175], a[116:119], v[108:111], v[172:175]
    ds_read_b64_tr_b16 a[110:111], v19 offset:24832
    v_cvt_pk_bf16_f32 v40, v144, v145
    v_cvt_pk_bf16_f32 v41, v146, v147
    v_mfma_f32_16x16x32_bf16 v[176:179], a[120:123], v[104:107], v[176:179]
    ds_read_b64_tr_b16 a[112:113], v20 offset:16640
    v_cvt_pk_bf16_f32 v42, v148, v149
    v_cvt_pk_bf16_f32 v43, v150, v151
    v_mfma_f32_16x16x32_bf16 v[180:183], a[120:123], v[108:111], v[180:183]
    ds_read_b64_tr_b16 a[114:115], v20 offset:24832
    buffer_store_dwordx4 v[40:43], v1, s[28:31], s58 offen
    v_cvt_pk_bf16_f32 v44, v152, v153
    v_mfma_f32_16x16x32_bf16 v[184:187], a[124:127], v[104:107], v[184:187]
    ds_read_b64_tr_b16 a[116:117], v21 offset:16640
    v_cvt_pk_bf16_f32 v45, v154, v155
    v_cvt_pk_bf16_f32 v46, v156, v157
    v_mfma_f32_16x16x32_bf16 v[188:191], a[124:127], v[108:111], v[188:191]
    ds_read_b64_tr_b16 a[118:119], v21 offset:24832
    v_cvt_pk_bf16_f32 v47, v158, v159
    buffer_store_dwordx4 v[44:47], v1, s[28:31], s58 offen offset:2048
    s_waitcnt lgkmcnt(4)
    v_mfma_f32_16x16x32_bf16 v[192:195], a[96:99], v[96:99], v[192:195]
    ds_read_b64_tr_b16 a[120:121], v22 offset:16640
    v_cvt_pk_bf16_f32 v48, v160, v161
    v_cvt_pk_bf16_f32 v49, v162, v163
    v_mfma_f32_16x16x32_bf16 v[196:199], a[96:99], v[100:103], v[196:199]
    ds_read_b64_tr_b16 a[122:123], v22 offset:24832
    v_cvt_pk_bf16_f32 v50, v164, v165
    v_cvt_pk_bf16_f32 v51, v166, v167
    v_mfma_f32_16x16x32_bf16 v[200:203], a[100:103], v[96:99], v[200:203]
    ds_read_b64_tr_b16 a[124:125], v23 offset:16640
    buffer_store_dwordx4 v[48:51], v1, s[28:31], s59 offen
    v_cvt_pk_bf16_f32 v52, v168, v169
    v_mfma_f32_16x16x32_bf16 v[204:207], a[100:103], v[100:103], v[204:207]
    ds_read_b64_tr_b16 a[126:127], v23 offset:24832
    v_cvt_pk_bf16_f32 v53, v170, v171
    v_cvt_pk_bf16_f32 v54, v172, v173
    v_mfma_f32_16x16x32_bf16 v[208:211], a[104:107], v[96:99], v[208:211]
    ds_read_b64_tr_b16 a[96:97], v16 offset:33024
    v_cvt_pk_bf16_f32 v55, v174, v175
    buffer_store_dwordx4 v[52:55], v1, s[28:31], s59 offen offset:2048
    v_mfma_f32_16x16x32_bf16 v[212:215], a[104:107], v[100:103], v[212:215]
    ds_read_b64_tr_b16 a[98:99], v16 offset:41216
    v_cvt_pk_bf16_f32 v56, v176, v177
    v_cvt_pk_bf16_f32 v57, v178, v179
    v_mfma_f32_16x16x32_bf16 v[216:219], a[108:111], v[96:99], v[216:219]
    ds_read_b64_tr_b16 a[100:101], v17 offset:33024
    v_cvt_pk_bf16_f32 v58, v180, v181
    v_cvt_pk_bf16_f32 v59, v182, v183
    v_mfma_f32_16x16x32_bf16 v[220:223], a[108:111], v[100:103], v[220:223]
    ds_read_b64_tr_b16 a[102:103], v17 offset:41216
    buffer_store_dwordx4 v[56:59], v1, s[28:31], s60 offen
    s_waitcnt lgkmcnt(4)
    v_mfma_f32_16x16x32_bf16 v[224:227], a[112:115], v[96:99], v[224:227]
    ds_read_b64_tr_b16 a[104:105], v18 offset:33024
    v_cvt_pk_bf16_f32 v60, v184, v185
    v_cvt_pk_bf16_f32 v61, v186, v187
    v_mfma_f32_16x16x32_bf16 v[228:231], a[112:115], v[100:103], v[228:231]
    ds_read_b64_tr_b16 a[106:107], v18 offset:41216
    v_cvt_pk_bf16_f32 v62, v188, v189
    v_cvt_pk_bf16_f32 v63, v190, v191
    buffer_store_dwordx4 v[60:63], v1, s[28:31], s60 offen offset:2048
    v_mfma_f32_16x16x32_bf16 v[232:235], a[116:119], v[96:99], v[232:235]
    ds_read_b64_tr_b16 a[108:109], v19 offset:33024
    v_mfma_f32_16x16x32_bf16 v[236:239], a[116:119], v[100:103], v[236:239]
    ds_read_b64_tr_b16 a[110:111], v19 offset:41216
    v_mfma_f32_16x16x32_bf16 v[240:243], a[120:123], v[96:99], v[240:243]
    ds_read_b64_tr_b16 a[112:113], v20 offset:33024
    v_mfma_f32_16x16x32_bf16 v[244:247], a[120:123], v[100:103], v[244:247]
    ds_read_b64_tr_b16 a[114:115], v20 offset:41216
    s_lshl_b32 s73, s32, 13
    v_mfma_f32_16x16x32_bf16 v[248:251], a[124:127], v[96:99], v[248:251]
    ds_read_b64_tr_b16 a[116:117], v21 offset:33024
    s_add_u32 s73, s73, 0x8000
    v_mfma_f32_16x16x32_bf16 v[252:255], a[124:127], v[100:103], v[252:255]
    ds_read_b64_tr_b16 a[118:119], v21 offset:41216
    s_waitcnt lgkmcnt(4)
    v_mfma_f32_16x16x32_bf16 v[192:195], a[96:99], v[104:107], v[192:195]
    ds_read_b64_tr_b16 a[120:121], v22 offset:33024
    v_bfe_u32 v28, v0, 4, 1
    v_mfma_f32_16x16x32_bf16 v[196:199], a[96:99], v[108:111], v[196:199]
    ds_read_b64_tr_b16 a[122:123], v22 offset:41216
    v_lshrrev_b32 v29, 5, v0
    v_mfma_f32_16x16x32_bf16 v[200:203], a[100:103], v[104:107], v[200:203]
    ds_read_b64_tr_b16 a[124:125], v23 offset:33024
    v_lshl_add_u32 v28, v28, 1, v29
    v_mfma_f32_16x16x32_bf16 v[204:207], a[100:103], v[108:111], v[204:207]
    ds_read_b64_tr_b16 a[126:127], v23 offset:41216
    v_and_b32 v29, 7, v0
    v_mfma_f32_16x16x32_bf16 v[208:211], a[104:107], v[104:107], v[208:211]
    v_xor_b32 v28, v28, v29
    v_and_b32 v29, 15, v0
    v_mfma_f32_16x16x32_bf16 v[212:215], a[104:107], v[108:111], v[212:215]
    v_lshlrev_b32 v29, 8, v29
    v_add_u32 v29, s73, v29
    v_mfma_f32_16x16x32_bf16 v[216:219], a[108:111], v[104:107], v[216:219]
    v_lshl_add_u32 v24, v28, 4, v29
    v_xor_b32 v25, 64, v24
    v_mfma_f32_16x16x32_bf16 v[220:223], a[108:111], v[108:111], v[220:223]
    v_lshrrev_b32 v28, 4, v0
    s_waitcnt lgkmcnt(0)
    v_mfma_f32_16x16x32_bf16 v[224:227], a[112:115], v[104:107], v[224:227]
    v_and_b32 v29, 15, v0
    v_xor_b32 v29, v29, v28
    v_mfma_f32_16x16x32_bf16 v[228:231], a[112:115], v[108:111], v[228:231]
    v_lshlrev_b32 v28, 8, v28
    v_add_u32 v28, s73, v28
    v_mfma_f32_16x16x32_bf16 v[232:235], a[116:119], v[104:107], v[232:235]
    v_lshl_add_u32 v26, v29, 4, v28
    v_xor_b32 v27, 64, v26
    v_mfma_f32_16x16x32_bf16 v[236:239], a[116:119], v[108:111], v[236:239]
    v_mov_b32 v12, s42
    v_mov_b32 v13, s43
    v_mfma_f32_16x16x32_bf16 v[240:243], a[120:123], v[104:107], v[240:243]
    s_mov_b32 s37, 0x100000
    s_waitcnt vmcnt(0)
    buffer_store_dwordx2 v[12:13], off, s[12:15], s67 offset:8
    v_mfma_f32_16x16x32_bf16 v[244:247], a[120:123], v[108:111], v[244:247]
    v_mfma_f32_16x16x32_bf16 v[248:251], a[124:127], v[104:107], v[248:251]
    v_mfma_f32_16x16x32_bf16 v[252:255], a[124:127], v[108:111], v[252:255]
    buffer_load_dwordx4 v[112:115], off, s[12:15], s45 sc1
    s_cmp_lg_u32 s44, 0
    s_cbranch_scc1 L_slowpub
    s_branch L_pollw
L_poll:
    s_sub_u32 s37, s37, 1
    s_cbranch_scc1 L_go
    s_waitcnt vmcnt(0)
    buffer_load_dwordx4 v[112:115], off, s[12:15], s45 sc1
L_pollw:
    s_waitcnt vmcnt(0)
    v_readfirstlane_b32 s68, v112
    v_readfirstlane_b32 s69, v113
    v_readfirstlane_b32 s70, v114
    v_readfirstlane_b32 s71, v115
    s_cmp_eq_u64 s[68:69], s[42:43]
    s_cbranch_scc0 L_fix
    s_cmp_eq_u64 s[70:71], s[40:41]
    s_cbranch_scc0 L_poll
    s_cmp_lg_u32 s44, 0
    s_cbranch_scc1 L_acq
L_go:
    buffer_load_dwordx4 v[112:115], v8, s[12:15], s47 offen sc1
    buffer_load_dwordx4 v[32:35], v1, s[28:31], s53 offen sc1
    buffer_load_dwordx4 v[36:39], v1, s[28:31], s53 offen offset:2048 sc1
    buffer_load_dwordx4 v[40:43], v1, s[28:31], s54 offen sc1
    buffer_load_dwordx4 v[44:47], v1, s[28:31], s54 offen offset:2048 sc1
    buffer_load_dwordx4 v[48:51], v1, s[28:31], s55 offen sc1
    buffer_load_dwordx4 v[52:55], v1, s[28:31], s55 offen offset:2048 sc1
    buffer_load_dwordx4 v[56:59], v1, s[28:31], s56 offen sc1
    buffer_load_dwordx4 v[60:63], v1, s[28:31], s56 offen offset:2048 sc1
    s_mov_b32 s68, 0xffff0000
    s_waitcnt vmcnt(8)
    v_min_f32 v12, v2, v112
    v_min_f32 v13, v3, v113
    v_sub_f32 v116, v12, v2
    v_sub_f32 v118, v13, v3
    v_sub_f32 v120, v12, v112
    v_sub_f32 v122, v13, v113
    v_exp_f32 v116, v116
    v_exp_f32 v118, v118
    v_exp_f32 v120, v120
    v_exp_f32 v122, v122
    v_mul_f32 v12, v4, v116
    v_mul_f32 v13, v5, v118
    v_fma_f32 v12, v114, v120, v12
    v_fma_f32 v13, v115, v122, v13
    v_rcp_f32 v12, v12
    v_rcp_f32 v13, v13
    v_mul_f32 v116, v116, v12
    v_mul_f32 v118, v118, v13
    v_mul_f32 v120, v120, v12
    v_mul_f32 v122, v122, v13
    v_pk_mul_f32 v[192:193], v[192:193], v[116:117] op_sel_hi:[1,0]
    v_pk_mul_f32 v[194:195], v[194:195], v[116:117] op_sel_hi:[1,0]
    v_pk_mul_f32 v[200:201], v[200:201], v[116:117] op_sel_hi:[1,0]
    v_pk_mul_f32 v[202:203], v[202:203], v[116:117] op_sel_hi:[1,0]
    v_pk_mul_f32 v[208:209], v[208:209], v[116:117] op_sel_hi:[1,0]
    v_pk_mul_f32 v[210:211], v[210:211], v[116:117] op_sel_hi:[1,0]
    v_pk_mul_f32 v[216:217], v[216:217], v[116:117] op_sel_hi:[1,0]
    v_pk_mul_f32 v[218:219], v[218:219], v[116:117] op_sel_hi:[1,0]
    s_waitcnt vmcnt(7)
    v_lshlrev_b32 v128, 16, v32
    v_and_b32 v129, s68, v32
    v_lshlrev_b32 v130, 16, v33
    v_and_b32 v131, s68, v33
    s_waitcnt vmcnt(6)
    v_lshlrev_b32 v136, 16, v36
    v_and_b32 v137, s68, v36
    v_lshlrev_b32 v138, 16, v37
    v_and_b32 v139, s68, v37
    s_waitcnt vmcnt(5)
    v_lshlrev_b32 v144, 16, v40
    v_and_b32 v145, s68, v40
    v_lshlrev_b32 v146, 16, v41
    v_and_b32 v147, s68, v41
    s_waitcnt vmcnt(4)
    v_lshlrev_b32 v152, 16, v44
    v_and_b32 v153, s68, v44
    v_lshlrev_b32 v154, 16, v45
    v_and_b32 v155, s68, v45
    v_pk_fma_f32 v[192:193], v[128:129], v[120:121], v[192:193] op_sel_hi:[1,0,1]
    v_pk_fma_f32 v[194:195], v[130:131], v[120:121], v[194:195] op_sel_hi:[1,0,1]
    v_pk_fma_f32 v[200:201], v[136:137], v[120:121], v[200:201] op_sel_hi:[1,0,1]
    v_pk_fma_f32 v[202:203], v[138:139], v[120:121], v[202:203] op_sel_hi:[1,0,1]
    v_pk_fma_f32 v[208:209], v[144:145], v[120:121], v[208:209] op_sel_hi:[1,0,1]
    v_pk_fma_f32 v[210:211], v[146:147], v[120:121], v[210:211] op_sel_hi:[1,0,1]
    v_pk_fma_f32 v[216:217], v[152:153], v[120:121], v[216:217] op_sel_hi:[1,0,1]
    v_pk_fma_f32 v[218:219], v[154:155], v[120:121], v[218:219] op_sel_hi:[1,0,1]
    v_cvt_pk_bf16_f32 v64, v192, v193
    v_cvt_pk_bf16_f32 v65, v194, v195
    v_cvt_pk_bf16_f32 v66, v200, v201
    v_cvt_pk_bf16_f32 v67, v202, v203
    v_cvt_pk_bf16_f32 v68, v208, v209
    v_cvt_pk_bf16_f32 v69, v210, v211
    v_cvt_pk_bf16_f32 v70, v216, v217
    v_cvt_pk_bf16_f32 v71, v218, v219
    s_nop 0
    v_permlane16_swap_b32 v64, v66
    v_permlane16_swap_b32 v65, v67
    v_permlane16_swap_b32 v68, v70
    v_permlane16_swap_b32 v69, v71
    ds_write_b128 v24, v[64:67] offset:0
    ds_write_b128 v25, v[68:71] offset:0
    v_pk_mul_f32 v[224:225], v[224:225], v[116:117] op_sel_hi:[1,0]
    v_pk_mul_f32 v[226:227], v[226:227], v[116:117] op_sel_hi:[1,0]
    v_pk_mul_f32 v[232:233], v[232:233], v[116:117] op_sel_hi:[1,0]
    v_pk_mul_f32 v[234:235], v[234:235], v[116:117] op_sel_hi:[1,0]
    v_pk_mul_f32 v[240:241], v[240:241], v[116:117] op_sel_hi:[1,0]
    v_pk_mul_f32 v[242:243], v[242:243], v[116:117] op_sel_hi:[1,0]
    v_pk_mul_f32 v[248:249], v[248:249], v[116:117] op_sel_hi:[1,0]
    v_pk_mul_f32 v[250:251], v[250:251], v[116:117] op_sel_hi:[1,0]
    s_waitcnt vmcnt(3)
    v_lshlrev_b32 v160, 16, v48
    v_and_b32 v161, s68, v48
    v_lshlrev_b32 v162, 16, v49
    v_and_b32 v163, s68, v49
    s_waitcnt vmcnt(2)
    v_lshlrev_b32 v168, 16, v52
    v_and_b32 v169, s68, v52
    v_lshlrev_b32 v170, 16, v53
    v_and_b32 v171, s68, v53
    s_waitcnt vmcnt(1)
    v_lshlrev_b32 v176, 16, v56
    v_and_b32 v177, s68, v56
    v_lshlrev_b32 v178, 16, v57
    v_and_b32 v179, s68, v57
    s_waitcnt vmcnt(0)
    v_lshlrev_b32 v184, 16, v60
    v_and_b32 v185, s68, v60
    v_lshlrev_b32 v186, 16, v61
    v_and_b32 v187, s68, v61
    v_pk_fma_f32 v[224:225], v[160:161], v[120:121], v[224:225] op_sel_hi:[1,0,1]
    v_pk_fma_f32 v[226:227], v[162:163], v[120:121], v[226:227] op_sel_hi:[1,0,1]
    v_pk_fma_f32 v[232:233], v[168:169], v[120:121], v[232:233] op_sel_hi:[1,0,1]
    v_pk_fma_f32 v[234:235], v[170:171], v[120:121], v[234:235] op_sel_hi:[1,0,1]
    v_pk_fma_f32 v[240:241], v[176:177], v[120:121], v[240:241] op_sel_hi:[1,0,1]
    v_pk_fma_f32 v[242:243], v[178:179], v[120:121], v[242:243] op_sel_hi:[1,0,1]
    v_pk_fma_f32 v[248:249], v[184:185], v[120:121], v[248:249] op_sel_hi:[1,0,1]
    v_pk_fma_f32 v[250:251], v[186:187], v[120:121], v[250:251] op_sel_hi:[1,0,1]
    v_cvt_pk_bf16_f32 v72, v224, v225
    v_cvt_pk_bf16_f32 v73, v226, v227
    v_cvt_pk_bf16_f32 v74, v232, v233
    v_cvt_pk_bf16_f32 v75, v234, v235
    v_cvt_pk_bf16_f32 v76, v240, v241
    v_cvt_pk_bf16_f32 v77, v242, v243
    v_cvt_pk_bf16_f32 v78, v248, v249
    v_cvt_pk_bf16_f32 v79, v250, v251
    s_nop 0
    v_permlane16_swap_b32 v72, v74
    v_permlane16_swap_b32 v73, v75
    v_permlane16_swap_b32 v76, v78
    v_permlane16_swap_b32 v77, v79
    ds_write_b128 v24, v[72:75] offset:128
    ds_write_b128 v25, v[76:79] offset:128
    ds_read_b128 v[96:99], v26 offset:0
    ds_read_b128 v[100:103], v27 offset:1024
    ds_read_b128 v[104:107], v26 offset:2048
    ds_read_b128 v[108:111], v27 offset:3072
    s_waitcnt vmcnt(0)
    v_pk_mul_f32 v[196:197], v[196:197], v[118:119] op_sel_hi:[1,0]
    v_pk_mul_f32 v[198:199], v[198:199], v[118:119] op_sel_hi:[1,0]
    v_pk_mul_f32 v[204:205], v[204:205], v[118:119] op_sel_hi:[1,0]
    v_pk_mul_f32 v[206:207], v[206:207], v[118:119] op_sel_hi:[1,0]
    v_pk_mul_f32 v[212:213], v[212:213], v[118:119] op_sel_hi:[1,0]
    v_pk_mul_f32 v[214:215], v[214:215], v[118:119] op_sel_hi:[1,0]
    v_pk_mul_f32 v[220:221], v[220:221], v[118:119] op_sel_hi:[1,0]
    v_pk_mul_f32 v[222:223], v[222:223], v[118:119] op_sel_hi:[1,0]
    v_lshlrev_b32 v132, 16, v34
    v_and_b32 v133, s68, v34
    v_lshlrev_b32 v134, 16, v35
    v_and_b32 v135, s68, v35
    s_waitcnt lgkmcnt(3)
    buffer_store_dwordx4 v[96:99], v1, s[28:31], s53 offen
    v_lshlrev_b32 v140, 16, v38
    v_and_b32 v141, s68, v38
    v_lshlrev_b32 v142, 16, v39
    v_and_b32 v143, s68, v39
    v_lshlrev_b32 v148, 16, v42
    v_and_b32 v149, s68, v42
    v_lshlrev_b32 v150, 16, v43
    v_and_b32 v151, s68, v43
    v_lshlrev_b32 v156, 16, v46
    v_and_b32 v157, s68, v46
    v_lshlrev_b32 v158, 16, v47
    v_and_b32 v159, s68, v47
    v_pk_fma_f32 v[196:197], v[132:133], v[122:123], v[196:197] op_sel_hi:[1,0,1]
    v_pk_fma_f32 v[198:199], v[134:135], v[122:123], v[198:199] op_sel_hi:[1,0,1]
    v_pk_fma_f32 v[204:205], v[140:141], v[122:123], v[204:205] op_sel_hi:[1,0,1]
    v_pk_fma_f32 v[206:207], v[142:143], v[122:123], v[206:207] op_sel_hi:[1,0,1]
    v_pk_fma_f32 v[212:213], v[148:149], v[122:123], v[212:213] op_sel_hi:[1,0,1]
    s_waitcnt lgkmcnt(2)
    buffer_store_dwordx4 v[100:103], v1, s[28:31], s53 offen offset:2048
    v_pk_fma_f32 v[214:215], v[150:151], v[122:123], v[214:215] op_sel_hi:[1,0,1]
    v_pk_fma_f32 v[220:221], v[156:157], v[122:123], v[220:221] op_sel_hi:[1,0,1]
    v_pk_fma_f32 v[222:223], v[158:159], v[122:123], v[222:223] op_sel_hi:[1,0,1]
    v_cvt_pk_bf16_f32 v80, v196, v197
    v_cvt_pk_bf16_f32 v81, v198, v199
    v_cvt_pk_bf16_f32 v82, v204, v205
    v_cvt_pk_bf16_f32 v83, v206, v207
    v_cvt_pk_bf16_f32 v84, v212, v213
    v_cvt_pk_bf16_f32 v85, v214, v215
    v_cvt_pk_bf16_f32 v86, v220, v221
    v_cvt_pk_bf16_f32 v87, v222, v223
    s_nop 0
    v_permlane16_swap_b32 v80, v82
    v_permlane16_swap_b32 v81, v83
    v_permlane16_swap_b32 v84, v86
    v_permlane16_swap_b32 v85, v87
    ds_write_b128 v24, v[80:83] offset:4096
    s_waitcnt lgkmcnt(2)
    buffer_store_dwordx4 v[104:107], v1, s[28:31], s54 offen
    ds_write_b128 v25, v[84:87] offset:4096
    v_pk_mul_f32 v[228:229], v[228:229], v[118:119] op_sel_hi:[1,0]
    v_pk_mul_f32 v[230:231], v[230:231], v[118:119] op_sel_hi:[1,0]
    v_pk_mul_f32 v[236:237], v[236:237], v[118:119] op_sel_hi:[1,0]
    v_pk_mul_f32 v[238:239], v[238:239], v[118:119] op_sel_hi:[1,0]
    v_pk_mul_f32 v[244:245], v[244:245], v[118:119] op_sel_hi:[1,0]
    v_pk_mul_f32 v[246:247], v[246:247], v[118:119] op_sel_hi:[1,0]
    v_pk_mul_f32 v[252:253], v[252:253], v[118:119] op_sel_hi:[1,0]
    v_pk_mul_f32 v[254:255], v[254:255], v[118:119] op_sel_hi:[1,0]
    v_lshlrev_b32 v164, 16, v50
    v_and_b32 v165, s68, v50
    v_lshlrev_b32 v166, 16, v51
    v_and_b32 v167, s68, v51
    v_lshlrev_b32 v172, 16, v54
    v_and_b32 v173, s68, v54
    v_lshlrev_b32 v174, 16, v55
    v_and_b32 v175, s68, v55
    s_waitcnt lgkmcnt(2)
    buffer_store_dwordx4 v[108:111], v1, s[28:31], s54 offen offset:2048
    v_lshlrev_b32 v180, 16, v58
    v_and_b32 v181, s68, v58
    v_lshlrev_b32 v182, 16, v59
    v_and_b32 v183, s68, v59
    v_lshlrev_b32 v188, 16, v62
    v_and_b32 v189, s68, v62
    v_lshlrev_b32 v190, 16, v63
    v_and_b32 v191, s68, v63
    v_pk_fma_f32 v[228:229], v[164:165], v[122:123], v[228:229] op_sel_hi:[1,0,1]
    v_pk_fma_f32 v[230:231], v[166:167], v[122:123], v[230:231] op_sel_hi:[1,0,1]
    v_pk_fma_f32 v[236:237], v[172:173], v[122:123], v[236:237] op_sel_hi:[1,0,1]
    v_pk_fma_f32 v[238:239], v[174:175], v[122:123], v[238:239] op_sel_hi:[1,0,1]
    v_pk_fma_f32 v[244:245], v[180:181], v[122:123], v[244:245] op_sel_hi:[1,0,1]
    v_pk_fma_f32 v[246:247], v[182:183], v[122:123], v[246:247] op_sel_hi:[1,0,1]
    v_pk_fma_f32 v[252:253], v[188:189], v[122:123], v[252:253] op_sel_hi:[1,0,1]
    v_pk_fma_f32 v[254:255], v[190:191], v[122:123], v[254:255] op_sel_hi:[1,0,1]
    v_cvt_pk_bf16_f32 v88, v228, v229
    v_cvt_pk_bf16_f32 v89, v230, v231
    v_cvt_pk_bf16_f32 v90, v236, v237
    v_cvt_pk_bf16_f32 v91, v238, v239
    v_cvt_pk_bf16_f32 v92, v244, v245
    v_cvt_pk_bf16_f32 v93, v246, v247
    v_cvt_pk_bf16_f32 v94, v252, v253
    v_cvt_pk_bf16_f32 v95, v254, v255
    s_nop 0
    v_permlane16_swap_b32 v88, v90
    v_permlane16_swap_b32 v89, v91
    v_permlane16_swap_b32 v92, v94
    v_permlane16_swap_b32 v93, v95
    ds_write_b128 v24, v[88:91] offset:4224
    ds_write_b128 v25, v[92:95] offset:4224
    ds_read_b128 v[64:67], v26 offset:4096
    ds_read_b128 v[68:71], v27 offset:5120
    ds_read_b128 v[72:75], v26 offset:6144
    ds_read_b128 v[76:79], v27 offset:7168
    s_waitcnt lgkmcnt(3)
    buffer_store_dwordx4 v[64:67], v1, s[28:31], s55 offen
    s_waitcnt lgkmcnt(2)
    buffer_store_dwordx4 v[68:71], v1, s[28:31], s55 offen offset:2048
    s_waitcnt lgkmcnt(1)
    buffer_store_dwordx4 v[72:75], v1, s[28:31], s56 offen
    s_waitcnt lgkmcnt(0)
    buffer_store_dwordx4 v[76:79], v1, s[28:31], s56 offen offset:2048
L_end:
    s_endpgm
L_fix:
    s_mov_b32 s42, s68
    s_mov_b32 s43, s69
    s_mov_b32 s44, 1
    v_mov_b32 v12, s42
    v_mov_b32 v13, s43
L_slowpub:
    s_waitcnt vmcnt(0)
    buffer_wbl2 sc1
    s_waitcnt vmcnt(0)
    buffer_store_dwordx2 v[12:13], off, s[12:15], s46 offset:8 sc1
    s_branch L_poll
L_acq:
    buffer_inv sc1
    s_waitcnt vmcnt(0)
    s_branch L_go
L_rare0:
    s_nop 7
    v_max3_f32 v12, v80, v81, v82
    v_max3_f32 v12, v12, v83, v84
    v_max3_f32 v12, v12, v85, v86
    v_max_f32 v12, v12, v87
    v_mov_b32 v13, v12
    s_nop 1
    v_permlane16_swap_b32 v12, v13
    s_nop 1
    v_max_f32 v12, v12, v13
    v_mov_b32 v13, v12
    s_nop 1
    v_permlane32_swap_b32 v12, v13
    s_nop 1
    v_max_f32 v12, v12, v13
    v_max_f32 v12, 0, v12
    v_exp_f32 v13, -v12
    v_sub_f32 v2, v2, v12
    v_mov_b32 v48, v2
    v_mov_b32 v49, v2
    v_mov_b32 v50, v2
    v_mov_b32 v51, v2
    v_sub_f32 v80, v80, v12
    v_sub_f32 v81, v81, v12
    v_sub_f32 v82, v82, v12
    v_sub_f32 v83, v83, v12
    v_sub_f32 v84, v84, v12
    v_sub_f32 v85, v85, v12
    v_sub_f32 v86, v86, v12
    v_sub_f32 v87, v87, v12
    v_mul_f32 v4, v4, v13
    v_mul_f32 v128, v128, v13
    v_mul_f32 v129, v129, v13
    v_mul_f32 v130, v130, v13
    v_mul_f32 v131, v131, v13
    v_mul_f32 v136, v136, v13
    v_mul_f32 v137, v137, v13
    v_mul_f32 v138, v138, v13
    v_mul_f32 v139, v139, v13
    v_mul_f32 v144, v144, v13
    v_mul_f32 v145, v145, v13
    v_mul_f32 v146, v146, v13
    v_mul_f32 v147, v147, v13
    v_mul_f32 v152, v152, v13
    v_mul_f32 v153, v153, v13
    v_mul_f32 v154, v154, v13
    v_mul_f32 v155, v155, v13
    v_mul_f32 v160, v160, v13
    v_mul_f32 v161, v161, v13
    v_mul_f32 v162, v162, v13
    v_mul_f32 v163, v163, v13
    v_mul_f32 v168, v168, v13
    v_mul_f32 v169, v169, v13
    v_mul_f32 v170, v170, v13
    v_mul_f32 v171, v171, v13
    v_mul_f32 v176, v176, v13
    v_mul_f32 v177, v177, v13
    v_mul_f32 v178, v178, v13
    v_mul_f32 v179, v179, v13
    v_mul_f32 v184, v184, v13
    v_mul_f32 v185, v185, v13
    v_mul_f32 v186, v186, v13
    v_mul_f32 v187, v187, v13
    v_mul_f32 v192, v192, v13
    v_mul_f32 v193, v193, v13
    v_mul_f32 v194, v194, v13
    v_mul_f32 v195, v195, v13
    v_mul_f32 v200, v200, v13
    v_mul_f32 v201, v201, v13
    v_mul_f32 v202, v202, v13
    v_mul_f32 v203, v203, v13
    v_mul_f32 v208, v208, v13
    v_mul_f32 v209, v209, v13
    v_mul_f32 v210, v210, v13
    v_mul_f32 v211, v211, v13
    v_mul_f32 v216, v216, v13
    v_mul_f32 v217, v217, v13
    v_mul_f32 v218, v218, v13
    v_mul_f32 v219, v219, v13
    v_mul_f32 v224, v224, v13
    v_mul_f32 v225, v225, v13
    v_mul_f32 v226, v226, v13
    v_mul_f32 v227, v227, v13
    v_mul_f32 v232, v232, v13
    v_mul_f32 v233, v233, v13
    v_mul_f32 v234, v234, v13
    v_mul_f32 v235, v235, v13
    v_mul_f32 v240, v240, v13
    v_mul_f32 v241, v241, v13
    v_mul_f32 v242, v242, v13
    v_mul_f32 v243, v243, v13
    v_mul_f32 v248, v248, v13
    v_mul_f32 v249, v249, v13
    v_mul_f32 v250, v250, v13
    v_mul_f32 v251, v251, v13
    v_max3_f32 v12, v88, v89, v90
    v_max3_f32 v12, v12, v91, v92
    v_max3_f32 v12, v12, v93, v94
    v_max_f32 v12, v12, v95
    v_mov_b32 v13, v12
    s_nop 1
    v_permlane16_swap_b32 v12, v13
    s_nop 1
    v_max_f32 v12, v12, v13
    v_mov_b32 v13, v12
    s_nop 1
    v_permlane32_swap_b32 v12, v13
    s_nop 1
    v_max_f32 v12, v12, v13
    v_max_f32 v12, 0, v12
    v_exp_f32 v13, -v12
    v_sub_f32 v3, v3, v12
    v_mov_b32 v52, v3
    v_mov_b32 v53, v3
    v_mov_b32 v54, v3
    v_mov_b32 v55, v3
    v_sub_f32 v88, v88, v12
    v_sub_f32 v89, v89, v12
    v_sub_f32 v90, v90, v12
    v_sub_f32 v91, v91, v12
    v_sub_f32 v92, v92, v12
    v_sub_f32 v93, v93, v12
    v_sub_f32 v94, v94, v12
    v_sub_f32 v95, v95, v12
    v_mul_f32 v5, v5, v13
    v_mul_f32 v132, v132, v13
    v_mul_f32 v133, v133, v13
    v_mul_f32 v134, v134, v13
    v_mul_f32 v135, v135, v13
    v_mul_f32 v140, v140, v13
    v_mul_f32 v141, v141, v13
    v_mul_f32 v142, v142, v13
    v_mul_f32 v143, v143, v13
    v_mul_f32 v148, v148, v13
    v_mul_f32 v149, v149, v13
    v_mul_f32 v150, v150, v13
    v_mul_f32 v151, v151, v13
    v_mul_f32 v156, v156, v13
    v_mul_f32 v157, v157, v13
    v_mul_f32 v158, v158, v13
    v_mul_f32 v159, v159, v13
    v_mul_f32 v164, v164, v13
    v_mul_f32 v165, v165, v13
    v_mul_f32 v166, v166, v13
    v_mul_f32 v167, v167, v13
    v_mul_f32 v172, v172, v13
    v_mul_f32 v173, v173, v13
    v_mul_f32 v174, v174, v13
    v_mul_f32 v175, v175, v13
    v_mul_f32 v180, v180, v13
    v_mul_f32 v181, v181, v13
    v_mul_f32 v182, v182, v13
    v_mul_f32 v183, v183, v13
    v_mul_f32 v188, v188, v13
    v_mul_f32 v189, v189, v13
    v_mul_f32 v190, v190, v13
    v_mul_f32 v191, v191, v13
    v_mul_f32 v196, v196, v13
    v_mul_f32 v197, v197, v13
    v_mul_f32 v198, v198, v13
    v_mul_f32 v199, v199, v13
    v_mul_f32 v204, v204, v13
    v_mul_f32 v205, v205, v13
    v_mul_f32 v206, v206, v13
    v_mul_f32 v207, v207, v13
    v_mul_f32 v212, v212, v13
    v_mul_f32 v213, v213, v13
    v_mul_f32 v214, v214, v13
    v_mul_f32 v215, v215, v13
    v_mul_f32 v220, v220, v13
    v_mul_f32 v221, v221, v13
    v_mul_f32 v222, v222, v13
    v_mul_f32 v223, v223, v13
    v_mul_f32 v228, v228, v13
    v_mul_f32 v229, v229, v13
    v_mul_f32 v230, v230, v13
    v_mul_f32 v231, v231, v13
    v_mul_f32 v236, v236, v13
    v_mul_f32 v237, v237, v13
    v_mul_f32 v238, v238, v13
    v_mul_f32 v239, v239, v13
    v_mul_f32 v244, v244, v13
    v_mul_f32 v245, v245, v13
    v_mul_f32 v246, v246, v13
    v_mul_f32 v247, v247, v13
    v_mul_f32 v252, v252, v13
    v_mul_f32 v253, v253, v13
    v_mul_f32 v254, v254, v13
    v_mul_f32 v255, v255, v13
    v_exp_f32 v112, v80
    v_exp_f32 v113, v81
    v_exp_f32 v114, v82
    v_exp_f32 v115, v83
    v_add_f32 v6, v112, v113
    v_cvt_pk_bf16_f32 v104, v112, v113
    v_exp_f32 v120, v88
    v_add_f32 v6, v6, v114
    v_exp_f32 v121, v89
    v_add_f32 v6, v6, v115
    v_cvt_pk_bf16_f32 v105, v114, v115
    v_exp_f32 v122, v90
    v_exp_f32 v123, v91
    v_add_f32 v7, v120, v121
    v_cvt_pk_bf16_f32 v108, v120, v121
    v_exp_f32 v116, v84
    v_add_f32 v7, v7, v122
    v_exp_f32 v117, v85
    v_add_f32 v7, v7, v123
    v_cvt_pk_bf16_f32 v109, v122, v123
    v_exp_f32 v118, v86
    v_add_f32 v6, v6, v116
    v_exp_f32 v119, v87
    v_add_f32 v6, v6, v117
    v_cvt_pk_bf16_f32 v106, v116, v117
    v_exp_f32 v124, v92
    v_add_f32 v6, v6, v118
    v_exp_f32 v125, v93
    v_add_f32 v6, v6, v119
    v_cvt_pk_bf16_f32 v107, v118, v119
    v_exp_f32 v126, v94
    v_add_f32 v7, v7, v124
    v_exp_f32 v127, v95
    v_add_f32 v7, v7, v125
    v_cvt_pk_bf16_f32 v110, v124, v125
    v_add_f32 v7, v7, v126
    v_add_f32 v7, v7, v127
    v_cvt_pk_bf16_f32 v111, v126, v127
    s_nop 1
    s_branch L_back0
L_rare1:
    s_nop 7
    v_max3_f32 v12, v64, v65, v66
    v_max3_f32 v12, v12, v67, v68
    v_max3_f32 v12, v12, v69, v70
    v_max_f32 v12, v12, v71
    v_mov_b32 v13, v12
    s_nop 1
    v_permlane16_swap_b32 v12, v13
    s_nop 1
    v_max_f32 v12, v12, v13
    v_mov_b32 v13, v12
    s_nop 1
    v_permlane32_swap_b32 v12, v13
    s_nop 1
    v_max_f32 v12, v12, v13
    v_max_f32 v12, 0, v12
    v_exp_f32 v13, -v12
    v_sub_f32 v2, v2, v12
    v_mov_b32 v48, v2
    v_mov_b32 v49, v2
    v_mov_b32 v50, v2
    v_mov_b32 v51, v2
    v_sub_f32 v64, v64, v12
    v_sub_f32 v65, v65, v12
    v_sub_f32 v66, v66, v12
    v_sub_f32 v67, v67, v12
    v_sub_f32 v68, v68, v12
    v_sub_f32 v69, v69, v12
    v_sub_f32 v70, v70, v12
    v_sub_f32 v71, v71, v12
    v_mul_f32 v4, v4, v13
    v_mul_f32 v128, v128, v13
    v_mul_f32 v129, v129, v13
    v_mul_f32 v130, v130, v13
    v_mul_f32 v131, v131, v13
    v_mul_f32 v136, v136, v13
    v_mul_f32 v137, v137, v13
    v_mul_f32 v138, v138, v13
    v_mul_f32 v139, v139, v13
    v_mul_f32 v144, v144, v13
    v_mul_f32 v145, v145, v13
    v_mul_f32 v146, v146, v13
    v_mul_f32 v147, v147, v13
    v_mul_f32 v152, v152, v13
    v_mul_f32 v153, v153, v13
    v_mul_f32 v154, v154, v13
    v_mul_f32 v155, v155, v13
    v_mul_f32 v160, v160, v13
    v_mul_f32 v161, v161, v13
    v_mul_f32 v162, v162, v13
    v_mul_f32 v163, v163, v13
    v_mul_f32 v168, v168, v13
    v_mul_f32 v169, v169, v13
    v_mul_f32 v170, v170, v13
    v_mul_f32 v171, v171, v13
    v_mul_f32 v176, v176, v13
    v_mul_f32 v177, v177, v13
    v_mul_f32 v178, v178, v13
    v_mul_f32 v179, v179, v13
    v_mul_f32 v184, v184, v13
    v_mul_f32 v185, v185, v13
    v_mul_f32 v186, v186, v13
    v_mul_f32 v187, v187, v13
    v_mul_f32 v192, v192, v13
    v_mul_f32 v193, v193, v13
    v_mul_f32 v194, v194, v13
    v_mul_f32 v195, v195, v13
    v_mul_f32 v200, v200, v13
    v_mul_f32 v201, v201, v13
    v_mul_f32 v202, v202, v13
    v_mul_f32 v203, v203, v13
    v_mul_f32 v208, v208, v13
    v_mul_f32 v209, v209, v13
    v_mul_f32 v210, v210, v13
    v_mul_f32 v211, v211, v13
    v_mul_f32 v216, v216, v13
    v_mul_f32 v217, v217, v13
    v_mul_f32 v218, v218, v13
    v_mul_f32 v219, v219, v13
    v_mul_f32 v224, v224, v13
    v_mul_f32 v225, v225, v13
    v_mul_f32 v226, v226, v13
    v_mul_f32 v227, v227, v13
    v_mul_f32 v232, v232, v13
    v_mul_f32 v233, v233, v13
    v_mul_f32 v234, v234, v13
    v_mul_f32 v235, v235, v13
    v_mul_f32 v240, v240, v13
    v_mul_f32 v241, v241, v13
    v_mul_f32 v242, v242, v13
    v_mul_f32 v243, v243, v13
    v_mul_f32 v248, v248, v13
    v_mul_f32 v249, v249, v13
    v_mul_f32 v250, v250, v13
    v_mul_f32 v251, v251, v13
    v_max3_f32 v12, v72, v73, v74
    v_max3_f32 v12, v12, v75, v76
    v_max3_f32 v12, v12, v77, v78
    v_max_f32 v12, v12, v79
    v_mov_b32 v13, v12
    s_nop 1
    v_permlane16_swap_b32 v12, v13
    s_nop 1
    v_max_f32 v12, v12, v13
    v_mov_b32 v13, v12
    s_nop 1
    v_permlane32_swap_b32 v12, v13
    s_nop 1
    v_max_f32 v12, v12, v13
    v_max_f32 v12, 0, v12
    v_exp_f32 v13, -v12
    v_sub_f32 v3, v3, v12
    v_mov_b32 v52, v3
    v_mov_b32 v53, v3
    v_mov_b32 v54, v3
    v_mov_b32 v55, v3
    v_sub_f32 v72, v72, v12
    v_sub_f32 v73, v73, v12
    v_sub_f32 v74, v74, v12
    v_sub_f32 v75, v75, v12
    v_sub_f32 v76, v76, v12
    v_sub_f32 v77, v77, v12
    v_sub_f32 v78, v78, v12
    v_sub_f32 v79, v79, v12
    v_mul_f32 v5, v5, v13
    v_mul_f32 v132, v132, v13
    v_mul_f32 v133, v133, v13
    v_mul_f32 v134, v134, v13
    v_mul_f32 v135, v135, v13
    v_mul_f32 v140, v140, v13
    v_mul_f32 v141, v141, v13
    v_mul_f32 v142, v142, v13
    v_mul_f32 v143, v143, v13
    v_mul_f32 v148, v148, v13
    v_mul_f32 v149, v149, v13
    v_mul_f32 v150, v150, v13
    v_mul_f32 v151, v151, v13
    v_mul_f32 v156, v156, v13
    v_mul_f32 v157, v157, v13
    v_mul_f32 v158, v158, v13
    v_mul_f32 v159, v159, v13
    v_mul_f32 v164, v164, v13
    v_mul_f32 v165, v165, v13
    v_mul_f32 v166, v166, v13
    v_mul_f32 v167, v167, v13
    v_mul_f32 v172, v172, v13
    v_mul_f32 v173, v173, v13
    v_mul_f32 v174, v174, v13
    v_mul_f32 v175, v175, v13
    v_mul_f32 v180, v180, v13
    v_mul_f32 v181, v181, v13
    v_mul_f32 v182, v182, v13
    v_mul_f32 v183, v183, v13
    v_mul_f32 v188, v188, v13
    v_mul_f32 v189, v189, v13
    v_mul_f32 v190, v190, v13
    v_mul_f32 v191, v191, v13
    v_mul_f32 v196, v196, v13
    v_mul_f32 v197, v197, v13
    v_mul_f32 v198, v198, v13
    v_mul_f32 v199, v199, v13
    v_mul_f32 v204, v204, v13
    v_mul_f32 v205, v205, v13
    v_mul_f32 v206, v206, v13
    v_mul_f32 v207, v207, v13
    v_mul_f32 v212, v212, v13
    v_mul_f32 v213, v213, v13
    v_mul_f32 v214, v214, v13
    v_mul_f32 v215, v215, v13
    v_mul_f32 v220, v220, v13
    v_mul_f32 v221, v221, v13
    v_mul_f32 v222, v222, v13
    v_mul_f32 v223, v223, v13
    v_mul_f32 v228, v228, v13
    v_mul_f32 v229, v229, v13
    v_mul_f32 v230, v230, v13
    v_mul_f32 v231, v231, v13
    v_mul_f32 v236, v236, v13
    v_mul_f32 v237, v237, v13
    v_mul_f32 v238, v238, v13
    v_mul_f32 v239, v239, v13
    v_mul_f32 v244, v244, v13
    v_mul_f32 v245, v245, v13
    v_mul_f32 v246, v246, v13
    v_mul_f32 v247, v247, v13
    v_mul_f32 v252, v252, v13
    v_mul_f32 v253, v253, v13
    v_mul_f32 v254, v254, v13
    v_mul_f32 v255, v255, v13
    v_exp_f32 v112, v64
    v_exp_f32 v113, v65
    v_exp_f32 v114, v66
    v_exp_f32 v115, v67
    v_add_f32 v6, v112, v113
    v_cvt_pk_bf16_f32 v96, v112, v113
    v_exp_f32 v120, v72
    v_add_f32 v6, v6, v114
    v_exp_f32 v121, v73
    v_add_f32 v6, v6, v115
    v_cvt_pk_bf16_f32 v97, v114, v115
    v_exp_f32 v122, v74
    v_exp_f32 v123, v75
    v_add_f32 v7, v120, v121
    v_cvt_pk_bf16_f32 v100, v120, v121
    v_exp_f32 v116, v68
    v_add_f32 v7, v7, v122
    v_exp_f32 v117, v69
    v_add_f32 v7, v7, v123
    v_cvt_pk_bf16_f32 v101, v122, v123
    v_exp_f32 v118, v70
    v_add_f32 v6, v6, v116
    v_exp_f32 v119, v71
    v_add_f32 v6, v6, v117
    v_cvt_pk_bf16_f32 v98, v116, v117
    v_exp_f32 v124, v76
    v_add_f32 v6, v6, v118
    v_exp_f32 v125, v77
    v_add_f32 v6, v6, v119
    v_cvt_pk_bf16_f32 v99, v118, v119
    v_exp_f32 v126, v78
    v_add_f32 v7, v7, v124
    v_exp_f32 v127, v79
    v_add_f32 v7, v7, v125
    v_cvt_pk_bf16_f32 v102, v124, v125
    v_add_f32 v7, v7, v126
    v_add_f32 v7, v7, v127
    v_cvt_pk_bf16_f32 v103, v126, v127
    s_nop 1
    s_branch L_back1
L_rare2:
    s_nop 7
    v_max3_f32 v12, v80, v81, v82
    v_max3_f32 v12, v12, v83, v84
    v_max3_f32 v12, v12, v85, v86
    v_max_f32 v12, v12, v87
    v_mov_b32 v13, v12
    s_nop 1
    v_permlane16_swap_b32 v12, v13
    s_nop 1
    v_max_f32 v12, v12, v13
    v_mov_b32 v13, v12
    s_nop 1
    v_permlane32_swap_b32 v12, v13
    s_nop 1
    v_max_f32 v12, v12, v13
    v_max_f32 v12, 0, v12
    v_exp_f32 v13, -v12
    v_sub_f32 v2, v2, v12
    v_mov_b32 v48, v2
    v_mov_b32 v49, v2
    v_mov_b32 v50, v2
    v_mov_b32 v51, v2
    v_sub_f32 v80, v80, v12
    v_sub_f32 v81, v81, v12
    v_sub_f32 v82, v82, v12
    v_sub_f32 v83, v83, v12
    v_sub_f32 v84, v84, v12
    v_sub_f32 v85, v85, v12
    v_sub_f32 v86, v86, v12
    v_sub_f32 v87, v87, v12
    v_sub_f32 v64, v64, v12
    v_sub_f32 v65, v65, v12
    v_sub_f32 v66, v66, v12
    v_sub_f32 v67, v67, v12
    v_mul_f32 v4, v4, v13
    v_mul_f32 v128, v128, v13
    v_mul_f32 v129, v129, v13
    v_mul_f32 v130, v130, v13
    v_mul_f32 v131, v131, v13
    v_mul_f32 v136, v136, v13
    v_mul_f32 v137, v137, v13
    v_mul_f32 v138, v138, v13
    v_mul_f32 v139, v139, v13
    v_mul_f32 v144, v144, v13
    v_mul_f32 v145, v145, v13
    v_mul_f32 v146, v146, v13
    v_mul_f32 v147, v147, v13
    v_mul_f32 v152, v152, v13
    v_mul_f32 v153, v153, v13
    v_mul_f32 v154, v154, v13
    v_mul_f32 v155, v155, v13
    v_mul_f32 v160, v160, v13
    v_mul_f32 v161, v161, v13
    v_mul_f32 v162, v162, v13
    v_mul_f32 v163, v163, v13
    v_mul_f32 v168, v168, v13
    v_mul_f32 v169, v169, v13
    v_mul_f32 v170, v170, v13
    v_mul_f32 v171, v171, v13
    v_mul_f32 v176, v176, v13
    v_mul_f32 v177, v177, v13
    v_mul_f32 v178, v178, v13
    v_mul_f32 v179, v179, v13
    v_mul_f32 v184, v184, v13
    v_mul_f32 v185, v185, v13
    v_mul_f32 v186, v186, v13
    v_mul_f32 v187, v187, v13
    v_mul_f32 v192, v192, v13
    v_mul_f32 v193, v193, v13
    v_mul_f32 v194, v194, v13
    v_mul_f32 v195, v195, v13
    v_mul_f32 v200, v200, v13
    v_mul_f32 v201, v201, v13
    v_mul_f32 v202, v202, v13
    v_mul_f32 v203, v203, v13
    v_mul_f32 v208, v208, v13
    v_mul_f32 v209, v209, v13
    v_mul_f32 v210, v210, v13
    v_mul_f32 v211, v211, v13
    v_mul_f32 v216, v216, v13
    v_mul_f32 v217, v217, v13
    v_mul_f32 v218, v218, v13
    v_mul_f32 v219, v219, v13
    v_mul_f32 v224, v224, v13
    v_mul_f32 v225, v225, v13
    v_mul_f32 v226, v226, v13
    v_mul_f32 v227, v227, v13
    v_mul_f32 v232, v232, v13
    v_mul_f32 v233, v233, v13
    v_mul_f32 v234, v234, v13
    v_mul_f32 v235, v235, v13
    v_mul_f32 v240, v240, v13
    v_mul_f32 v241, v241, v13
    v_mul_f32 v242, v242, v13
    v_mul_f32 v243, v243, v13
    v_mul_f32 v248, v248, v13
    v_mul_f32 v249, v249, v13
    v_mul_f32 v250, v250, v13
    v_mul_f32 v251, v251, v13
    v_max3_f32 v12, v88, v89, v90
    v_max3_f32 v12, v12, v91, v92
    v_max3_f32 v12, v12, v93, v94
    v_max_f32 v12, v12, v95
    v_mov_b32 v13, v12
    s_nop 1
    v_permlane16_swap_b32 v12, v13
    s_nop 1
    v_max_f32 v12, v12, v13
    v_mov_b32 v13, v12
    s_nop 1
    v_permlane32_swap_b32 v12, v13
    s_nop 1
    v_max_f32 v12, v12, v13
    v_max_f32 v12, 0, v12
    v_exp_f32 v13, -v12
    v_sub_f32 v3, v3, v12
    v_mov_b32 v52, v3
    v_mov_b32 v53, v3
    v_mov_b32 v54, v3
    v_mov_b32 v55, v3
    v_sub_f32 v88, v88, v12
    v_sub_f32 v89, v89, v12
    v_sub_f32 v90, v90, v12
    v_sub_f32 v91, v91, v12
    v_sub_f32 v92, v92, v12
    v_sub_f32 v93, v93, v12
    v_sub_f32 v94, v94, v12
    v_sub_f32 v95, v95, v12
    v_sub_f32 v72, v72, v12
    v_sub_f32 v73, v73, v12
    v_sub_f32 v74, v74, v12
    v_sub_f32 v75, v75, v12
    v_mul_f32 v5, v5, v13
    v_mul_f32 v132, v132, v13
    v_mul_f32 v133, v133, v13
    v_mul_f32 v134, v134, v13
    v_mul_f32 v135, v135, v13
    v_mul_f32 v140, v140, v13
    v_mul_f32 v141, v141, v13
    v_mul_f32 v142, v142, v13
    v_mul_f32 v143, v143, v13
    v_mul_f32 v148, v148, v13
    v_mul_f32 v149, v149, v13
    v_mul_f32 v150, v150, v13
    v_mul_f32 v151, v151, v13
    v_mul_f32 v156, v156, v13
    v_mul_f32 v157, v157, v13
    v_mul_f32 v158, v158, v13
    v_mul_f32 v159, v159, v13
    v_mul_f32 v164, v164, v13
    v_mul_f32 v165, v165, v13
    v_mul_f32 v166, v166, v13
    v_mul_f32 v167, v167, v13
    v_mul_f32 v172, v172, v13
    v_mul_f32 v173, v173, v13
    v_mul_f32 v174, v174, v13
    v_mul_f32 v175, v175, v13
    v_mul_f32 v180, v180, v13
    v_mul_f32 v181, v181, v13
    v_mul_f32 v182, v182, v13
    v_mul_f32 v183, v183, v13
    v_mul_f32 v188, v188, v13
    v_mul_f32 v189, v189, v13
    v_mul_f32 v190, v190, v13
    v_mul_f32 v191, v191, v13
    v_mul_f32 v196, v196, v13
    v_mul_f32 v197, v197, v13
    v_mul_f32 v198, v198, v13
    v_mul_f32 v199, v199, v13
    v_mul_f32 v204, v204, v13
    v_mul_f32 v205, v205, v13
    v_mul_f32 v206, v206, v13
    v_mul_f32 v207, v207, v13
    v_mul_f32 v212, v212, v13
    v_mul_f32 v213, v213, v13
    v_mul_f32 v214, v214, v13
    v_mul_f32 v215, v215, v13
    v_mul_f32 v220, v220, v13
    v_mul_f32 v221, v221, v13
    v_mul_f32 v222, v222, v13
    v_mul_f32 v223, v223, v13
    v_mul_f32 v228, v228, v13
    v_mul_f32 v229, v229, v13
    v_mul_f32 v230, v230, v13
    v_mul_f32 v231, v231, v13
    v_mul_f32 v236, v236, v13
    v_mul_f32 v237, v237, v13
    v_mul_f32 v238, v238, v13
    v_mul_f32 v239, v239, v13
    v_mul_f32 v244, v244, v13
    v_mul_f32 v245, v245, v13
    v_mul_f32 v246, v246, v13
    v_mul_f32 v247, v247, v13
    v_mul_f32 v252, v252, v13
    v_mul_f32 v253, v253, v13
    v_mul_f32 v254, v254, v13
    v_mul_f32 v255, v255, v13
    v_exp_f32 v112, v80
    v_exp_f32 v113, v81
    v_exp_f32 v114, v82
    v_exp_f32 v115, v83
    v_add_f32 v6, v112, v113
    v_cvt_pk_bf16_f32 v104, v112, v113
    v_exp_f32 v120, v88
    v_add_f32 v6, v6, v114
    v_exp_f32 v121, v89
    v_add_f32 v6, v6, v115
    v_cvt_pk_bf16_f32 v105, v114, v115
    v_exp_f32 v122, v90
    v_exp_f32 v123, v91
    v_add_f32 v7, v120, v121
    v_cvt_pk_bf16_f32 v108, v120, v121
    v_exp_f32 v116, v84
    v_add_f32 v7, v7, v122
    v_exp_f32 v117, v85
    v_add_f32 v7, v7, v123
    v_cvt_pk_bf16_f32 v109, v122, v123
    v_exp_f32 v118, v86
    v_add_f32 v6, v6, v116
    v_exp_f32 v119, v87
    v_add_f32 v6, v6, v117
    v_cvt_pk_bf16_f32 v106, v116, v117
    v_exp_f32 v124, v92
    v_add_f32 v6, v6, v118
    v_exp_f32 v125, v93
    v_add_f32 v6, v6, v119
    v_cvt_pk_bf16_f32 v107, v118, v119
    v_exp_f32 v126, v94
    v_add_f32 v7, v7, v124
    v_exp_f32 v127, v95
    v_add_f32 v7, v7, v125
    v_cvt_pk_bf16_f32 v110, v124, v125
    v_add_f32 v7, v7, v126
    v_add_f32 v7, v7, v127
    v_cvt_pk_bf16_f32 v111, v126, v127
    s_nop 1
    s_branch L_back2
L_rare3:
    s_nop 7
    v_max3_f32 v12, v64, v65, v66
    v_max3_f32 v12, v12, v67, v68
    v_max3_f32 v12, v12, v69, v70
    v_max_f32 v12, v12, v71
    v_mov_b32 v13, v12
    s_nop 1
    v_permlane16_swap_b32 v12, v13
    s_nop 1
    v_max_f32 v12, v12, v13
    v_mov_b32 v13, v12
    s_nop 1
    v_permlane32_swap_b32 v12, v13
    s_nop 1
    v_max_f32 v12, v12, v13
    v_max_f32 v12, 0, v12
    v_exp_f32 v13, -v12
    v_sub_f32 v2, v2, v12
    v_mov_b32 v48, v2
    v_mov_b32 v49, v2
    v_mov_b32 v50, v2
    v_mov_b32 v51, v2
    v_sub_f32 v64, v64, v12
    v_sub_f32 v65, v65, v12
    v_sub_f32 v66, v66, v12
    v_sub_f32 v67, v67, v12
    v_sub_f32 v68, v68, v12
    v_sub_f32 v69, v69, v12
    v_sub_f32 v70, v70, v12
    v_sub_f32 v71, v71, v12
    v_sub_f32 v80, v80, v12
    v_sub_f32 v81, v81, v12
    v_sub_f32 v82, v82, v12
    v_sub_f32 v83, v83, v12
    v_mul_f32 v4, v4, v13
    v_mul_f32 v128, v128, v13
    v_mul_f32 v129, v129, v13
    v_mul_f32 v130, v130, v13
    v_mul_f32 v131, v131, v13
    v_mul_f32 v136, v136, v13
    v_mul_f32 v137, v137, v13
    v_mul_f32 v138, v138, v13
    v_mul_f32 v139, v139, v13
    v_mul_f32 v144, v144, v13
    v_mul_f32 v145, v145, v13
    v_mul_f32 v146, v146, v13
    v_mul_f32 v147, v147, v13
    v_mul_f32 v152, v152, v13
    v_mul_f32 v153, v153, v13
    v_mul_f32 v154, v154, v13
    v_mul_f32 v155, v155, v13
    v_mul_f32 v160, v160, v13
    v_mul_f32 v161, v161, v13
    v_mul_f32 v162, v162, v13
    v_mul_f32 v163, v163, v13
    v_mul_f32 v168, v168, v13
    v_mul_f32 v169, v169, v13
    v_mul_f32 v170, v170, v13
    v_mul_f32 v171, v171, v13
    v_mul_f32 v176, v176, v13
    v_mul_f32 v177, v177, v13
    v_mul_f32 v178, v178, v13
    v_mul_f32 v179, v179, v13
    v_mul_f32 v184, v184, v13
    v_mul_f32 v185, v185, v13
    v_mul_f32 v186, v186, v13
    v_mul_f32 v187, v187, v13
    v_mul_f32 v192, v192, v13
    v_mul_f32 v193, v193, v13
    v_mul_f32 v194, v194, v13
    v_mul_f32 v195, v195, v13
    v_mul_f32 v200, v200, v13
    v_mul_f32 v201, v201, v13
    v_mul_f32 v202, v202, v13
    v_mul_f32 v203, v203, v13
    v_mul_f32 v208, v208, v13
    v_mul_f32 v209, v209, v13
    v_mul_f32 v210, v210, v13
    v_mul_f32 v211, v211, v13
    v_mul_f32 v216, v216, v13
    v_mul_f32 v217, v217, v13
    v_mul_f32 v218, v218, v13
    v_mul_f32 v219, v219, v13
    v_mul_f32 v224, v224, v13
    v_mul_f32 v225, v225, v13
    v_mul_f32 v226, v226, v13
    v_mul_f32 v227, v227, v13
    v_mul_f32 v232, v232, v13
    v_mul_f32 v233, v233, v13
    v_mul_f32 v234, v234, v13
    v_mul_f32 v235, v235, v13
    v_mul_f32 v240, v240, v13
    v_mul_f32 v241, v241, v13
    v_mul_f32 v242, v242, v13
    v_mul_f32 v243, v243, v13
    v_mul_f32 v248, v248, v13
    v_mul_f32 v249, v249, v13
    v_mul_f32 v250, v250, v13
    v_mul_f32 v251, v251, v13
    v_max3_f32 v12, v72, v73, v74
    v_max3_f32 v12, v12, v75, v76
    v_max3_f32 v12, v12, v77, v78
    v_max_f32 v12, v12, v79
    v_mov_b32 v13, v12
    s_nop 1
    v_permlane16_swap_b32 v12, v13
    s_nop 1
    v_max_f32 v12, v12, v13
    v_mov_b32 v13, v12
    s_nop 1
    v_permlane32_swap_b32 v12, v13
    s_nop 1
    v_max_f32 v12, v12, v13
    v_max_f32 v12, 0, v12
    v_exp_f32 v13, -v12
    v_sub_f32 v3, v3, v12
    v_mov_b32 v52, v3
    v_mov_b32 v53, v3
    v_mov_b32 v54, v3
    v_mov_b32 v55, v3
    v_sub_f32 v72, v72, v12
    v_sub_f32 v73, v73, v12
    v_sub_f32 v74, v74, v12
    v_sub_f32 v75, v75, v12
    v_sub_f32 v76, v76, v12
    v_sub_f32 v77, v77, v12
    v_sub_f32 v78, v78, v12
    v_sub_f32 v79, v79, v12
    v_sub_f32 v88, v88, v12
    v_sub_f32 v89, v89, v12
    v_sub_f32 v90, v90, v12
    v_sub_f32 v91, v91, v12
    v_mul_f32 v5, v5, v13
    v_mul_f32 v132, v132, v13
    v_mul_f32 v133, v133, v13
    v_mul_f32 v134, v134, v13
    v_mul_f32 v135, v135, v13
    v_mul_f32 v140, v140, v13
    v_mul_f32 v141, v141, v13
    v_mul_f32 v142, v142, v13
    v_mul_f32 v143, v143, v13
    v_mul_f32 v148, v148, v13
    v_mul_f32 v149, v149, v13
    v_mul_f32 v150, v150, v13
    v_mul_f32 v151, v151, v13
    v_mul_f32 v156, v156, v13
    v_mul_f32 v157, v157, v13
    v_mul_f32 v158, v158, v13
    v_mul_f32 v159, v159, v13
    v_mul_f32 v164, v164, v13
    v_mul_f32 v165, v165, v13
    v_mul_f32 v166, v166, v13
    v_mul_f32 v167, v167, v13
    v_mul_f32 v172, v172, v13
    v_mul_f32 v173, v173, v13
    v_mul_f32 v174, v174, v13
    v_mul_f32 v175, v175, v13
    v_mul_f32 v180, v180, v13
    v_mul_f32 v181, v181, v13
    v_mul_f32 v182, v182, v13
    v_mul_f32 v183, v183, v13
    v_mul_f32 v188, v188, v13
    v_mul_f32 v189, v189, v13
    v_mul_f32 v190, v190, v13
    v_mul_f32 v191, v191, v13
    v_mul_f32 v196, v196, v13
    v_mul_f32 v197, v197, v13
    v_mul_f32 v198, v198, v13
    v_mul_f32 v199, v199, v13
    v_mul_f32 v204, v204, v13
    v_mul_f32 v205, v205, v13
    v_mul_f32 v206, v206, v13
    v_mul_f32 v207, v207, v13
    v_mul_f32 v212, v212, v13
    v_mul_f32 v213, v213, v13
    v_mul_f32 v214, v214, v13
    v_mul_f32 v215, v215, v13
    v_mul_f32 v220, v220, v13
    v_mul_f32 v221, v221, v13
    v_mul_f32 v222, v222, v13
    v_mul_f32 v223, v223, v13
    v_mul_f32 v228, v228, v13
    v_mul_f32 v229, v229, v13
    v_mul_f32 v230, v230, v13
    v_mul_f32 v231, v231, v13
    v_mul_f32 v236, v236, v13
    v_mul_f32 v237, v237, v13
    v_mul_f32 v238, v238, v13
    v_mul_f32 v239, v239, v13
    v_mul_f32 v244, v244, v13
    v_mul_f32 v245, v245, v13
    v_mul_f32 v246, v246, v13
    v_mul_f32 v247, v247, v13
    v_mul_f32 v252, v252, v13
    v_mul_f32 v253, v253, v13
    v_mul_f32 v254, v254, v13
    v_mul_f32 v255, v255, v13
    v_exp_f32 v112, v64
    v_exp_f32 v113, v65
    v_exp_f32 v114, v66
    v_exp_f32 v115, v67
    v_add_f32 v6, v112, v113
    v_cvt_pk_bf16_f32 v96, v112, v113
    v_exp_f32 v120, v72
    v_add_f32 v6, v6, v114
    v_exp_f32 v121, v73
    v_add_f32 v6, v6, v115
    v_cvt_pk_bf16_f32 v97, v114, v115
    v_exp_f32 v122, v74
    v_exp_f32 v123, v75
    v_add_f32 v7, v120, v121
    v_cvt_pk_bf16_f32 v100, v120, v121
    v_exp_f32 v116, v68
    v_add_f32 v7, v7, v122
    v_exp_f32 v117, v69
    v_add_f32 v7, v7, v123
    v_cvt_pk_bf16_f32 v101, v122, v123
    v_exp_f32 v118, v70
    v_add_f32 v6, v6, v116
    v_exp_f32 v119, v71
    v_add_f32 v6, v6, v117
    v_cvt_pk_bf16_f32 v98, v116, v117
    v_exp_f32 v124, v76
    v_add_f32 v6, v6, v118
    v_exp_f32 v125, v77
    v_add_f32 v6, v6, v119
    v_cvt_pk_bf16_f32 v99, v118, v119
    v_exp_f32 v126, v78
    v_add_f32 v7, v7, v124
    v_exp_f32 v127, v79
    v_add_f32 v7, v7, v125
    v_cvt_pk_bf16_f32 v102, v124, v125
    v_add_f32 v7, v7, v126
    v_add_f32 v7, v7, v127
    v_cvt_pk_bf16_f32 v103, v126, v127
    s_nop 1
    s_branch L_back3
L_rare4:
    s_nop 7
    v_max3_f32 v12, v80, v81, v82
    v_max3_f32 v12, v12, v83, v84
    v_max3_f32 v12, v12, v85, v86
    v_max_f32 v12, v12, v87
    v_mov_b32 v13, v12
    s_nop 1
    v_permlane16_swap_b32 v12, v13
    s_nop 1
    v_max_f32 v12, v12, v13
    v_mov_b32 v13, v12
    s_nop 1
    v_permlane32_swap_b32 v12, v13
    s_nop 1
    v_max_f32 v12, v12, v13
    v_max_f32 v12, 0, v12
    v_exp_f32 v13, -v12
    v_sub_f32 v2, v2, v12
    v_mov_b32 v48, v2
    v_mov_b32 v49, v2
    v_mov_b32 v50, v2
    v_mov_b32 v51, v2
    v_sub_f32 v80, v80, v12
    v_sub_f32 v81, v81, v12
    v_sub_f32 v82, v82, v12
    v_sub_f32 v83, v83, v12
    v_sub_f32 v84, v84, v12
    v_sub_f32 v85, v85, v12
    v_sub_f32 v86, v86, v12
    v_sub_f32 v87, v87, v12
    v_mul_f32 v4, v4, v13
    v_lshlrev_b32 v14, 16, v96
    v_and_b32 v15, 0xffff0000, v96
    v_mul_f32 v14, v14, v13
    v_mul_f32 v15, v15, v13
    v_cvt_pk_bf16_f32 v96, v14, v15
    v_lshlrev_b32 v14, 16, v97
    v_and_b32 v15, 0xffff0000, v97
    v_mul_f32 v14, v14, v13
    v_mul_f32 v15, v15, v13
    v_cvt_pk_bf16_f32 v97, v14, v15
    v_lshlrev_b32 v14, 16, v98
    v_and_b32 v15, 0xffff0000, v98
    v_mul_f32 v14, v14, v13
    v_mul_f32 v15, v15, v13
    v_cvt_pk_bf16_f32 v98, v14, v15
    v_lshlrev_b32 v14, 16, v99
    v_and_b32 v15, 0xffff0000, v99
    v_mul_f32 v14, v14, v13
    v_mul_f32 v15, v15, v13
    v_cvt_pk_bf16_f32 v99, v14, v15
    v_mul_f32 v128, v128, v13
    v_mul_f32 v129, v129, v13
    v_mul_f32 v130, v130, v13
    v_mul_f32 v131, v131, v13
    v_mul_f32 v136, v136, v13
    v_mul_f32 v137, v137, v13
    v_mul_f32 v138, v138, v13
    v_mul_f32 v139, v139, v13
    v_mul_f32 v144, v144, v13
    v_mul_f32 v145, v145, v13
    v_mul_f32 v146, v146, v13
    v_mul_f32 v147, v147, v13
    v_mul_f32 v152, v152, v13
    v_mul_f32 v153, v153, v13
    v_mul_f32 v154, v154, v13
    v_mul_f32 v155, v155, v13
    v_mul_f32 v160, v160, v13
    v_mul_f32 v161, v161, v13
    v_mul_f32 v162, v162, v13
    v_mul_f32 v163, v163, v13
    v_mul_f32 v168, v168, v13
    v_mul_f32 v169, v169, v13
    v_mul_f32 v170, v170, v13
    v_mul_f32 v171, v171, v13
    v_mul_f32 v176, v176, v13
    v_mul_f32 v177, v177, v13
    v_mul_f32 v178, v178, v13
    v_mul_f32 v179, v179, v13
    v_mul_f32 v184, v184, v13
    v_mul_f32 v185, v185, v13
    v_mul_f32 v186, v186, v13
    v_mul_f32 v187, v187, v13
    v_mul_f32 v192, v192, v13
    v_mul_f32 v193, v193, v13
    v_mul_f32 v194, v194, v13
    v_mul_f32 v195, v195, v13
    v_mul_f32 v200, v200, v13
    v_mul_f32 v201, v201, v13
    v_mul_f32 v202, v202, v13
    v_mul_f32 v203, v203, v13
    v_mul_f32 v208, v208, v13
    v_mul_f32 v209, v209, v13
    v_mul_f32 v210, v210, v13
    v_mul_f32 v211, v211, v13
    v_mul_f32 v216, v216, v13
    v_mul_f32 v217, v217, v13
    v_mul_f32 v218, v218, v13
    v_mul_f32 v219, v219, v13
    v_mul_f32 v224, v224, v13
    v_mul_f32 v225, v225, v13
    v_mul_f32 v226, v226, v13
    v_mul_f32 v227, v227, v13
    v_mul_f32 v232, v232, v13
    v_mul_f32 v233, v233, v13
    v_mul_f32 v234, v234, v13
    v_mul_f32 v235, v235, v13
    v_mul_f32 v240, v240, v13
    v_mul_f32 v241, v241, v13
    v_mul_f32 v242, v242, v13
    v_mul_f32 v243, v243, v13
    v_mul_f32 v248, v248, v13
    v_mul_f32 v249, v249, v13
    v_mul_f32 v250, v250, v13
    v_mul_f32 v251, v251, v13
    v_max3_f32 v12, v88, v89, v90
    v_max3_f32 v12, v12, v91, v92
    v_max3_f32 v12, v12, v93, v94
    v_max_f32 v12, v12, v95
    v_mov_b32 v13, v12
    s_nop 1
    v_permlane16_swap_b32 v12, v13
    s_nop 1
    v_max_f32 v12, v12, v13
    v_mov_b32 v13, v12
    s_nop 1
    v_permlane32_swap_b32 v12, v13
    s_nop 1
    v_max_f32 v12, v12, v13
    v_max_f32 v12, 0, v12
    v_exp_f32 v13, -v12
    v_sub_f32 v3, v3, v12
    v_mov_b32 v52, v3
    v_mov_b32 v53, v3
    v_mov_b32 v54, v3
    v_mov_b32 v55, v3
    v_sub_f32 v88, v88, v12
    v_sub_f32 v89, v89, v12
    v_sub_f32 v90, v90, v12
    v_sub_f32 v91, v91, v12
    v_sub_f32 v92, v92, v12
    v_sub_f32 v93, v93, v12
    v_sub_f32 v94, v94, v12
    v_sub_f32 v95, v95, v12
    v_mul_f32 v5, v5, v13
    v_lshlrev_b32 v14, 16, v100
    v_and_b32 v15, 0xffff0000, v100
    v_mul_f32 v14, v14, v13
    v_mul_f32 v15, v15, v13
    v_cvt_pk_bf16_f32 v100, v14, v15
    v_lshlrev_b32 v14, 16, v101
    v_and_b32 v15, 0xffff0000, v101
    v_mul_f32 v14, v14, v13
    v_mul_f32 v15, v15, v13
    v_cvt_pk_bf16_f32 v101, v14, v15
    v_lshlrev_b32 v14, 16, v102
    v_and_b32 v15, 0xffff0000, v102
    v_mul_f32 v14, v14, v13
    v_mul_f32 v15, v15, v13
    v_cvt_pk_bf16_f32 v102, v14, v15
    v_lshlrev_b32 v14, 16, v103
    v_and_b32 v15, 0xffff0000, v103
    v_mul_f32 v14, v14, v13
    v_mul_f32 v15, v15, v13
    v_cvt_pk_bf16_f32 v103, v14, v15
    v_mul_f32 v132, v132, v13
    v_mul_f32 v133, v133, v13
    v_mul_f32 v134, v134, v13
    v_mul_f32 v135, v135, v13
    v_mul_f32 v140, v140, v13
    v_mul_f32 v141, v141, v13
    v_mul_f32 v142, v142, v13
    v_mul_f32 v143, v143, v13
    v_mul_f32 v148, v148, v13
    v_mul_f32 v149, v149, v13
    v_mul_f32 v150, v150, v13
    v_mul_f32 v151, v151, v13
    v_mul_f32 v156, v156, v13
    v_mul_f32 v157, v157, v13
    v_mul_f32 v158, v158, v13
    v_mul_f32 v159, v159, v13
    v_mul_f32 v164, v164, v13
    v_mul_f32 v165, v165, v13
    v_mul_f32 v166, v166, v13
    v_mul_f32 v167, v167, v13
    v_mul_f32 v172, v172, v13
    v_mul_f32 v173, v173, v13
    v_mul_f32 v174, v174, v13
    v_mul_f32 v175, v175, v13
    v_mul_f32 v180, v180, v13
    v_mul_f32 v181, v181, v13
    v_mul_f32 v182, v182, v13
    v_mul_f32 v183, v183, v13
    v_mul_f32 v188, v188, v13
    v_mul_f32 v189, v189, v13
    v_mul_f32 v190, v190, v13
    v_mul_f32 v191, v191, v13
    v_mul_f32 v196, v196, v13
    v_mul_f32 v197, v197, v13
    v_mul_f32 v198, v198, v13
    v_mul_f32 v199, v199, v13
    v_mul_f32 v204, v204, v13
    v_mul_f32 v205, v205, v13
    v_mul_f32 v206, v206, v13
    v_mul_f32 v207, v207, v13
    v_mul_f32 v212, v212, v13
    v_mul_f32 v213, v213, v13
    v_mul_f32 v214, v214, v13
    v_mul_f32 v215, v215, v13
    v_mul_f32 v220, v220, v13
    v_mul_f32 v221, v221, v13
    v_mul_f32 v222, v222, v13
    v_mul_f32 v223, v223, v13
    v_mul_f32 v228, v228, v13
    v_mul_f32 v229, v229, v13
    v_mul_f32 v230, v230, v13
    v_mul_f32 v231, v231, v13
    v_mul_f32 v236, v236, v13
    v_mul_f32 v237, v237, v13
    v_mul_f32 v238, v238, v13
    v_mul_f32 v239, v239, v13
    v_mul_f32 v244, v244, v13
    v_mul_f32 v245, v245, v13
    v_mul_f32 v246, v246, v13
    v_mul_f32 v247, v247, v13
    v_mul_f32 v252, v252, v13
    v_mul_f32 v253, v253, v13
    v_mul_f32 v254, v254, v13
    v_mul_f32 v255, v255, v13
    v_exp_f32 v112, v80
    v_exp_f32 v113, v81
    v_exp_f32 v114, v82
    v_exp_f32 v115, v83
    v_add_f32 v6, v112, v113
    v_cvt_pk_bf16_f32 v104, v112, v113
    v_exp_f32 v120, v88
    v_add_f32 v6, v6, v114
    v_exp_f32 v121, v89
    v_add_f32 v6, v6, v115
    v_cvt_pk_bf16_f32 v105, v114, v115
    v_exp_f32 v122, v90
    v_exp_f32 v123, v91
    v_add_f32 v7, v120, v121
    v_cvt_pk_bf16_f32 v108, v120, v121
    v_exp_f32 v116, v84
    v_add_f32 v7, v7, v122
    v_exp_f32 v117, v85
    v_add_f32 v7, v7, v123
    v_cvt_pk_bf16_f32 v109, v122, v123
    v_exp_f32 v118, v86
    v_add_f32 v6, v6, v116
    v_exp_f32 v119, v87
    v_add_f32 v6, v6, v117
    v_cvt_pk_bf16_f32 v106, v116, v117
    v_exp_f32 v124, v92
    v_add_f32 v6, v6, v118
    v_exp_f32 v125, v93
    v_add_f32 v6, v6, v119
    v_cvt_pk_bf16_f32 v107, v118, v119
    v_exp_f32 v126, v94
    v_add_f32 v7, v7, v124
    v_exp_f32 v127, v95
    v_add_f32 v7, v7, v125
    v_cvt_pk_bf16_f32 v110, v124, v125
    v_add_f32 v7, v7, v126
    v_add_f32 v7, v7, v127
    v_cvt_pk_bf16_f32 v111, v126, v127
    s_nop 1
    s_branch L_back4
.section .rodata,"a"
.p2align 6
.amdhsa_kernel standalone__gqa_softmax__near_ridge_kernel
  .amdhsa_next_free_vgpr 392
  .amdhsa_next_free_sgpr 102
  .amdhsa_accum_offset 256
  .amdhsa_group_segment_fixed_size 0
  .amdhsa_kernarg_size 48
  .amdhsa_user_sgpr_count 2
  .amdhsa_user_sgpr_kernarg_segment_ptr 1
  .amdhsa_system_sgpr_workgroup_id_x 1
.end_amdhsa_kernel
```
